```python
import torch

def _softmax(x, axis=-1):
    return torch.softmax(x, dim=axis)
def _gelu(x):
    return torch.nn.functional.gelu(x, approximate="tanh")
def _silu(x):
    return torch.nn.functional.silu(x)
def _sigmoid(x):
    return torch.sigmoid(x)
def _layernorm(x, axis=-1, eps=1e-5):
    m = x.mean(dim=axis, keepdim=True)
    v = x.var(dim=axis, keepdim=True, unbiased=False)
    return (x - m) / torch.sqrt(v + eps)
def _scatter_add(tgt, idx, src, axis=0):
    return tgt.clone().index_add_(axis, idx, src)
def _segment_sum(src, seg, n):
    out = torch.zeros((n,) + src.shape[1:], dtype=src.dtype)
    return out.index_add_(0, seg, src)
def _pad(x, pw):
    flat = tuple(v for pair in reversed(pw) for v in pair)
    return torch.nn.functional.pad(x, flat)

kernel_name = 'standalone__cross_network_dcn__recsys'

def setup_inputs():

    _w = (lambda a: (lambda t: t.to(torch.bfloat16) if t.is_floating_point() else t)(torch.as_tensor(a)))
    B, F, D, L = 4096, 26, 32, 3
    Din = min(F * D, 1024)
    return {
        "x0": _w((lambda *s: torch.randn(*s, dtype=torch.bfloat16) * 0.05)(B, Din)),
        "ws": _w((lambda *s: torch.randn(*s, dtype=torch.bfloat16) * 0.8)(L, Din, Din) * (Din ** -0.5)),
        "bs": _w((lambda *s: torch.randn(*s, dtype=torch.bfloat16) * 3.2)(L, Din) * 0.01),
    }

def reference(x0, ws, bs):
    x = x0
    L = ws.shape[0]
    for l in range(L):
        proj = torch.einsum('bd,de->be', x, ws[l]) + bs[l]
        x = x0 * proj + x
    return x
```

```asm
; @launch grid=(256,1,1) block=(256,1,1) lds=162816
.amdgcn_target "amdgcn-amd-amdhsa--gfx950"
.text
.globl standalone__cross_network_dcn__recsys_kernel
.p2align 12
.type standalone__cross_network_dcn__recsys_kernel,@function
standalone__cross_network_dcn__recsys_kernel:
    s_cmp_ge_u32 s2, 256
    s_cbranch_scc1 L_end
    s_load_dwordx2 s[20:21], s[0:1], 8
    s_load_dwordx2 s[16:17], s[0:1], 0
    s_load_dwordx2 s[32:33], s[0:1], 16
    s_load_dwordx2 s[24:25], s[0:1], 40
    s_load_dwordx2 s[28:29], s[0:1], 24
    s_load_dwordx2 s[36:37], s[0:1], 32
    s_mov_b32 s22, 4153344
    s_mov_b32 s23, 0x00020000
    v_lshrrev_b32 v1, 6, v0
    v_and_b32 v2, 63, v0
    v_readfirstlane_b32 s3, v1
    s_lshr_b32 s51, s2, 3
    s_and_b32 s52, s2, 7
    s_cmp_ge_u32 s51, 28
    s_cbranch_scc1 L_prefetcher
    s_mul_i32 s53, s51, 9363
    s_lshr_b32 s53, s53, 16
    s_mul_i32 s54, s53, 7
    s_sub_u32 s48, s51, s54
    s_lshl_b32 s52, s52, 2
    s_add_u32 s49, s52, s53
    s_mul_i32 s40, s49, 212992
    s_lshl_b32 s43, s3, 11
    s_lshl_b32 s55, s48, 2
    s_add_u32 s55, s55, s3
    s_lshl_b32 s57, s48, 8
    s_mul_i32 s14, s53, 13
    s_lshr_b32 s14, s14, 2
    s_mul_i32 s12, s14, 106496
    s_mov_b32 s50, s53
    s_mov_b32 s45, s53
    v_and_b32 v3, 15, v2
    v_lshrrev_b32 v4, 4, v2
    s_and_b32 s54, s3, 1
    s_lshl_b32 s54, s54, 2
    s_cmp_eq_u32 s48, 6
    s_cselect_b32 s53, 8, 16
    s_lshl_b32 s56, s3, 3
    v_add_u32 v7, s56, v4
    v_or_b32 v8, s54, v4
    v_lshlrev_b32 v8, 1, v8
    v_xor_b32 v8, v8, v3
    v_mul_u32_u24 v7, 1664, v7
    v_lshlrev_b32 v9, 4, v8
    v_add3_u32 v7, v7, v9, s57
    v_cmp_gt_u32 vcc, s53, v8
    v_mov_b32 v9, 2147483392
    s_nop 0
    v_cndmask_b32 v246, v9, v7, vcc
    v_add_u32 v7, s56, v4
    v_add_u32 v7, 4, v7
    v_or_b32 v8, s54, v4
    v_lshlrev_b32 v8, 1, v8
    v_xor_b32 v8, v8, v3
    v_mul_u32_u24 v7, 1664, v7
    v_lshlrev_b32 v9, 4, v8
    v_add3_u32 v7, v7, v9, s57
    v_subrev_u32 v7, 1024, v7
    v_cmp_gt_u32 vcc, s53, v8
    v_mov_b32 v9, 2147483392
    s_nop 0
    v_cndmask_b32 v247, v9, v7, vcc
    s_waitcnt lgkmcnt(0)
    s_add_u32 m0, s43, 79872
    s_mov_b32 s47, s12
    buffer_load_dwordx4 v246, s[20:23], s47 offen lds
    buffer_load_dwordx4 v247, s[20:23], s47 offen offset:1024 lds
    s_add_u32 m0, s43, 88064
    s_add_u32 s46, s47, 53248
    s_sub_u32 s15, s46, 1384448
    s_min_u32 s46, s46, s15
    buffer_load_dwordx4 v246, s[20:23], s46 offen lds
    buffer_load_dwordx4 v247, s[20:23], s46 offen offset:1024 lds
    s_mov_b32 s18, 6815744
    s_mov_b32 s19, 0x00020000
    s_mov_b32 s34, 4992
    s_mov_b32 s35, 0x00020000
    s_mov_b32 s26, 19922944
    s_mov_b32 s27, 0x00020000
    s_mov_b32 s30, 6815744
    s_mov_b32 s31, 0x00020000
    s_mov_b32 s38, 256
    s_mov_b32 s39, 0x00020000
    s_mul_i32 s56, s3, 27
    s_add_u32 s56, s56, 2
    s_lshr_b32 s56, s56, 2
    s_lshl_b32 s44, s56, 10
    s_cmp_ge_u32 s3, 2
    s_cselect_b32 s52, 2147483392, 0
    s_cselect_b32 s11, 163856, s44
    s_add_u32 s13, s40, s52
    s_add_u32 s54, s56, 0
    s_lshr_b32 s54, s54, 1
    s_add_u32 s54, s54, s14
    s_sub_u32 s53, s54, 13
    s_min_u32 s54, s54, s53
    s_lshl_b32 s54, s54, 7
    s_add_u32 s4, s54, s40
    s_add_u32 s54, s56, 1
    s_lshr_b32 s54, s54, 1
    s_add_u32 s54, s54, s14
    s_sub_u32 s53, s54, 13
    s_min_u32 s54, s54, s53
    s_lshl_b32 s54, s54, 7
    s_add_u32 s5, s54, s40
    s_sub_u32 s5, s5, 1024
    s_add_u32 s54, s56, 2
    s_lshr_b32 s54, s54, 1
    s_add_u32 s54, s54, s14
    s_sub_u32 s53, s54, 13
    s_min_u32 s54, s54, s53
    s_lshl_b32 s54, s54, 7
    s_add_u32 s6, s54, s40
    s_sub_u32 s6, s6, 2048
    s_add_u32 s54, s56, 3
    s_lshr_b32 s54, s54, 1
    s_add_u32 s54, s54, s14
    s_sub_u32 s53, s54, 13
    s_min_u32 s54, s54, s53
    s_lshl_b32 s54, s54, 7
    s_add_u32 s7, s54, s40
    s_sub_u32 s7, s7, 3072
    s_add_u32 s54, s56, 4
    s_lshr_b32 s54, s54, 1
    s_add_u32 s54, s54, s14
    s_sub_u32 s53, s54, 13
    s_min_u32 s54, s54, s53
    s_lshl_b32 s54, s54, 7
    s_add_u32 s8, s54, s40
    s_add_u32 s54, s56, 5
    s_lshr_b32 s54, s54, 1
    s_add_u32 s54, s54, s14
    s_sub_u32 s53, s54, 13
    s_min_u32 s54, s54, s53
    s_lshl_b32 s54, s54, 7
    s_add_u32 s9, s54, s40
    s_sub_u32 s9, s9, 1024
    s_add_u32 s54, s56, 6
    s_lshr_b32 s54, s54, 1
    s_add_u32 s54, s54, s14
    s_sub_u32 s53, s54, 13
    s_min_u32 s54, s54, s53
    s_lshl_b32 s54, s54, 7
    s_add_u32 s10, s54, s13
    v_and_b32 v5, 7, v2
    v_lshrrev_b32 v6, 3, v2
    s_and_b32 s54, s56, 1
    s_lshl_b32 s54, s54, 3
    v_xor_b32 v8, s54, v6
    v_lshrrev_b32 v10, 1, v8
    v_xor_b32 v10, v10, v5
    v_lshlrev_b32 v10, 4, v10
    v_mul_u32_u24 v8, 1664, v8
    v_add_u32 v42, v8, v10
    v_xor_b32 v8, s54, v6
    v_xor_b32 v8, 8, v8
    v_lshrrev_b32 v10, 1, v8
    v_xor_b32 v10, v10, v5
    v_lshlrev_b32 v10, 4, v10
    v_mul_u32_u24 v8, 1664, v8
    v_add_u32 v253, v8, v10
    v_min_u32 v7, 6, v2
    s_cmp_ge_u32 s3, 2
    s_cselect_b32 s54, 5, 6
    v_min_u32 v7, s54, v2
    v_add_u32 v7, s56, v7
    v_lshlrev_b32 v46, 7, v7
    v_mov_b32 v11, 0
    v_bfe_u32 v7, v2, 1, 2
    s_lshl_b32 s54, s3, 2
    v_add_u32 v7, s54, v7
    v_mul_u32_u24 v7, 1664, v7
    v_and_b32 v8, 1, v2
    v_lshlrev_b32 v8, 7, v8
    v_add3_u32 v7, v7, v8, s57
    v_mov_b32 v8, 2147483392
    v_cmp_gt_u32 vcc, 8, v2
    s_nop 1
    v_cndmask_b32 v251, v8, v7, vcc
    s_lshl_b32 s56, s55, 6
    v_lshlrev_b32 v15, 3, v4
    v_add_u32 v15, s56, v15
    buffer_load_dword v47, v251, s[16:19], s40 offen
    s_mov_b32 s56, 18874368
    buffer_load_dword v12, v11, s[24:27], s56 offen sc1
    buffer_load_dwordx2 v[200:201], v15, s[32:35], 0 offen offset:0
    buffer_load_dwordx2 v[202:203], v15, s[32:35], 0 offen offset:32
    buffer_load_dwordx2 v[204:205], v15, s[32:35], 0 offen offset:1664
    buffer_load_dwordx2 v[206:207], v15, s[32:35], 0 offen offset:1696
    buffer_load_dwordx2 v[208:209], v15, s[32:35], 0 offen offset:3328
    buffer_load_dwordx2 v[210:211], v15, s[32:35], 0 offen offset:3360
    s_add_u32 m0, s43, 96256
    s_add_u32 s47, s46, 53248
    s_sub_u32 s15, s47, 1384448
    s_min_u32 s47, s47, s15
    buffer_load_dwordx4 v246, s[20:23], s47 offen lds
    s_mov_b32 s60, 0xffff0000
    s_mov_b32 s61, 53248
    s_mov_b32 s62, 1384448
    s_mov_b32 s63, 26624
    s_mov_b32 s64, 4096
    s_add_u32 s65, s43, 79872
    s_add_u32 s66, s43, 112640
    s_add_u32 s67, s44, 0
    s_add_u32 s32, s11, 6144
    s_add_u32 s68, s44, 26624
    buffer_load_dwordx4 v247, s[20:23], s47 offen offset:1024 lds
    s_add_u32 s33, s11, 32768
    s_add_u32 s69, s44, 53248
    s_add_u32 s34, s11, 59392
    s_lshl_b32 s35, s40, 1
    s_mov_b32 s1, s35
    s_add_u32 s0, s40, s13
    s_add_u32 s0, s0, 6144
    s_lshr_b32 s56, s50, 1
    s_mul_i32 s56, s56, 53248
    s_and_b32 s50, s50, 1
    s_mul_i32 s50, s50, 6656
    s_add_u32 m0, s43, 104448
    s_add_u32 s46, s47, 53248
    s_sub_u32 s15, s46, 1384448
    s_min_u32 s46, s46, s15
    buffer_load_dwordx4 v246, s[20:23], s46 offen lds
    s_add_u32 s50, s50, s56
    s_cmp_eq_u32 s48, 6
    s_cselect_b32 s53, 8, 16
    s_lshl_b32 s56, s3, 3
    v_add_u32 v7, s56, v4
    v_and_b32 v8, 7, v7
    v_lshlrev_b32 v8, 1, v8
    v_xor_b32 v8, v8, v3
    v_mul_u32_u24 v7, 1664, v7
    v_lshlrev_b32 v9, 4, v8
    v_add3_u32 v7, v7, v9, s57
    buffer_load_dwordx4 v247, s[20:23], s46 offen offset:1024 lds
    s_mov_b64 exec, 0
    s_cmp_eq_u32 s3, 0
    s_cbranch_scc1 L_page1
    s_cmp_eq_u32 s3, 1
    s_cbranch_scc1 L_page2
    s_cmp_eq_u32 s3, 2
    s_cbranch_scc1 L_page3
    s_branch L_page4
L_walk_back:
    s_mov_b64 exec, -1
    v_cmp_gt_u32 vcc, s53, v8
    v_mov_b32 v9, 2147483392
    s_nop 0
    v_cndmask_b32 v40, v9, v7, vcc
    v_add_u32 v7, s56, v4
    v_add_u32 v7, 4, v7
    v_and_b32 v8, 7, v7
    v_lshlrev_b32 v8, 1, v8
    v_xor_b32 v8, v8, v3
    v_mul_u32_u24 v7, 1664, v7
    v_lshlrev_b32 v9, 4, v8
    s_add_u32 m0, s43, 112640
    s_add_u32 s47, s46, 53248
    s_sub_u32 s15, s47, 1384448
    s_min_u32 s47, s47, s15
    buffer_load_dwordx4 v246, s[20:23], s47 offen lds
    v_add3_u32 v7, v7, v9, s57
    v_subrev_u32 v7, 1024, v7
    v_cmp_gt_u32 vcc, s53, v8
    v_mov_b32 v9, 2147483392
    s_nop 0
    v_cndmask_b32 v41, v9, v7, vcc
    s_lshl_b32 s49, s49, 16
    s_add_u32 s49, s49, 16773120
    v_lshrrev_b32 v8, 1, v3
    v_xor_b32 v8, v8, v4
    v_lshlrev_b32 v9, 7, v3
    buffer_load_dwordx4 v247, s[20:23], s47 offen offset:1024 lds
    v_lshl_add_u32 v36, v8, 4, v9
    v_xor_b32 v252, 64, v36
    s_lshl_b32 s56, s55, 2
    v_lshrrev_b32 v7, 1, v4
    v_add_u32 v7, s56, v7
    s_lshr_b32 s56, s55, 1
    s_sub_u32 s56, s56, s14
    s_add_u32 s52, s56, 13
    s_min_u32 s56, s56, s52
    s_lshl_b32 s56, s56, 11
    v_mov_b32 v8, s56
    s_add_u32 m0, s43, 120832
    s_add_u32 s46, s47, 53248
    s_sub_u32 s15, s46, 1384448
    s_min_u32 s46, s46, s15
    buffer_load_dwordx4 v246, s[20:23], s46 offen lds
    v_and_b32 v7, 7, v7
    v_lshrrev_b32 v10, 1, v3
    v_xor_b32 v7, v7, v10
    v_lshlrev_b32 v7, 4, v7
    v_add3_u32 v7, v7, v8, v9
    v_and_b32 v8, 1, v4
    v_lshl_add_u32 v254, v8, 3, v7
    v_min_u32 v254, 26616, v254
    v_xor_b32 v255, 32, v254
    v_lshrrev_b32 v7, 2, v2
    v_and_b32 v8, 7, v7
    buffer_load_dwordx4 v247, s[20:23], s46 offen offset:1024 lds
    v_lshlrev_b32 v8, 1, v8
    v_and_b32 v9, 3, v2
    v_lshrrev_b32 v10, 1, v9
    s_lshl_b32 s56, s3, 2
    v_add_u32 v10, s56, v10
    v_xor_b32 v10, v10, v8
    v_lshlrev_b32 v10, 4, v10
    v_and_b32 v9, 1, v9
    v_lshl_add_u32 v10, v9, 3, v10
    v_lshl_add_u32 v38, v7, 8, v10
    v_add_u32 v38, 79872, v38
    s_add_u32 m0, s44, 0
    s_add_u32 s54, s4, 0
    buffer_load_dwordx4 v42, s[16:19], s54 offen lds
    v_xor_b32 v39, 32, v38
    v_and_b32 v8, 3, v7
    v_lshl_add_u32 v8, v4, 3, v8
    v_lshl_add_u32 v244, v8, 8, v10
    v_add_u32 v244, 79872, v244
    v_xor_b32 v245, 32, v244
    v_lshlrev_b32 v13, 4, v2
    s_mov_b32 s52, s55
    s_lshl_b32 s56, s52, 10
    v_add_u32 v7, s56, v13
    s_cmp_lt_u32 s55, 26
    s_cselect_b32 s51, 0, 2147483392
    s_add_u32 m0, s44, 1024
    s_add_u32 s54, s5, 1024
    buffer_load_dwordx4 v253, s[16:19], s54 offen lds
    v_add_u32 v44, s51, v7
    s_lshl_b32 s56, s3, 10
    s_add_u32 s56, s56, 145408
    v_add_u32 v43, s56, v13
    s_lshl_b32 s56, s52, 7
    s_add_u32 s56, s56, s51
    v_lshlrev_b32 v7, 2, v2
    v_add_u32 v7, s56, v7
    v_mov_b32 v8, 2147483392
    v_cmp_gt_u32 vcc, 32, v2
    s_add_u32 m0, s44, 2048
    s_add_u32 s54, s6, 2048
    buffer_load_dwordx4 v42, s[16:19], s54 offen lds
    s_nop 1
    v_cndmask_b32 v45, v8, v7, vcc
    v_cmp_eq_u32 vcc, 0, v2
    s_nop 1
    v_cndmask_b32 v10, v8, v11, vcc
    s_mov_b32 s14, s49
    s_mov_b32 s53, s40
    s_lshl_b32 s56, s3, 8
    s_add_u32 s56, s56, 161792
    v_lshlrev_b32 v7, 4, v4
    v_add_u32 v7, s56, v7
    s_add_u32 m0, s44, 3072
    s_add_u32 s54, s7, 3072
    buffer_load_dwordx4 v253, s[16:19], s54 offen lds
    s_waitcnt vmcnt(12)
    v_lshlrev_b32 v16, 16, v200
    v_and_b32 v17, 0xffff0000, v200
    v_lshlrev_b32 v18, 16, v201
    v_and_b32 v19, 0xffff0000, v201
    s_add_u32 m0, s44, 4096
    s_add_u32 s54, s8, 0
    buffer_load_dwordx4 v42, s[16:19], s54 offen lds
    v_lshlrev_b32 v20, 16, v202
    v_and_b32 v21, 0xffff0000, v202
    v_lshlrev_b32 v22, 16, v203
    v_and_b32 v23, 0xffff0000, v203
    v_add_f32 v16, 1.0, v16
    s_add_u32 m0, s44, 5120
    s_add_u32 s54, s9, 1024
    buffer_load_dwordx4 v253, s[16:19], s54 offen lds
    v_add_f32 v17, 1.0, v17
    v_add_f32 v18, 1.0, v18
    v_add_f32 v19, 1.0, v19
    v_add_f32 v20, 1.0, v20
    s_add_u32 m0, s11, 6144
    s_add_u32 s54, s10, 0
    buffer_load_dwordx4 v42, s[16:19], s54 offen lds
    v_add_f32 v21, 1.0, v21
    v_add_f32 v22, 1.0, v22
    v_add_f32 v23, 1.0, v23
    v_lshlrev_b32 v216, 16, v204
    v_and_b32 v217, 0xffff0000, v204
    s_add_u32 m0, s43, 129024
    s_add_u32 s47, s46, 53248
    s_sub_u32 s15, s47, 1384448
    s_min_u32 s47, s47, s15
    buffer_load_dwordx4 v246, s[20:23], s47 offen lds
    v_lshlrev_b32 v218, 16, v205
    v_and_b32 v219, 0xffff0000, v205
    v_lshlrev_b32 v220, 16, v206
    v_and_b32 v221, 0xffff0000, v206
    buffer_load_dwordx4 v247, s[20:23], s47 offen offset:1024 lds
    v_lshlrev_b32 v222, 16, v207
    v_and_b32 v223, 0xffff0000, v207
    v_lshlrev_b32 v224, 16, v208
    v_and_b32 v225, 0xffff0000, v208
    v_lshlrev_b32 v226, 16, v209
    s_add_u32 m0, s43, 137216
    s_add_u32 s46, s47, 53248
    s_sub_u32 s15, s46, 1384448
    s_min_u32 s46, s46, s15
    buffer_load_dwordx4 v246, s[20:23], s46 offen lds
    v_and_b32 v227, 0xffff0000, v209
    v_lshlrev_b32 v228, 16, v210
    v_and_b32 v229, 0xffff0000, v210
    v_lshlrev_b32 v230, 16, v211
    v_and_b32 v231, 0xffff0000, v211
    s_mov_b32 exec_lo, 0x00010001
    s_mov_b32 exec_hi, 0x00010001
    ds_write_b128 v7, v[216:219] offset:0
    ds_write_b128 v7, v[220:223] offset:64
    ds_write_b128 v7, v[224:227] offset:128
    ds_write_b128 v7, v[228:231] offset:192
    s_mov_b64 exec, -1
    buffer_load_dwordx4 v247, s[20:23], s46 offen offset:1024 lds
    s_or_b32 s56, s2, s3
    s_cmp_eq_u32 s56, 0
    s_cbranch_scc0 L_nopub
    s_waitcnt vmcnt(25)
    v_add_u32 v14, 1, v12
    v_mov_b32 v15, 1
    s_mov_b32 s56, 18874368
    buffer_store_dword v14, v10, s[24:27], s56 offen sc1
    buffer_store_dwordx2 v[14:15], v10, s[36:39], 0 offen sc1
L_nopub:
    s_waitcnt vmcnt(15)
    s_barrier
    s_add_u32 m0, s43, 26624
    ds_read_b64_tr_b16 a[0:1], v244 offset:0
    ds_read_b64_tr_b16 a[2:3], v244 offset:1024
    s_add_u32 s47, s46, s61
    s_sub_u32 s15, s47, s62
    s_min_u32 s47, s47, s15
    buffer_load_dwordx4 v246, s[20:23], s47 offen lds
    ds_read_b64_tr_b16 a[4:5], v245 offset:0
    ds_read_b64_tr_b16 a[6:7], v245 offset:1024
    buffer_load_dwordx4 v247, s[20:23], s47 offen offset:1024 lds
    ds_read_b64_tr_b16 a[8:9], v244 offset:8192
    ds_read_b64_tr_b16 a[10:11], v244 offset:9216
    s_add_u32 m0, s43, 34816
    s_add_u32 s46, s47, s61
    s_sub_u32 s15, s46, s62
    s_min_u32 s46, s46, s15
    buffer_load_dwordx4 v246, s[20:23], s46 offen lds
    ds_read_b64_tr_b16 a[12:13], v245 offset:8192
    ds_read_b64_tr_b16 a[14:15], v245 offset:9216
    buffer_load_dwordx4 v247, s[20:23], s46 offen offset:1024 lds
    ds_read_b64_tr_b16 a[16:17], v244 offset:16384
    ds_read_b64_tr_b16 a[18:19], v244 offset:17408
    s_add_u32 m0, s43, 43008
    s_add_u32 s47, s46, s61
    s_sub_u32 s15, s47, s62
    s_min_u32 s47, s47, s15
    buffer_load_dwordx4 v246, s[20:23], s47 offen lds
    ds_read_b64_tr_b16 a[20:21], v245 offset:16384
    ds_read_b64_tr_b16 a[22:23], v245 offset:17408
    buffer_load_dwordx4 v247, s[20:23], s47 offen offset:1024 lds
    ds_read_b64_tr_b16 a[24:25], v244 offset:24576
    ds_read_b64_tr_b16 a[26:27], v244 offset:25600
    s_add_u32 m0, s43, 51200
    s_add_u32 s46, s47, s61
    s_sub_u32 s15, s46, s62
    s_min_u32 s46, s46, s15
    buffer_load_dwordx4 v246, s[20:23], s46 offen lds
    ds_read_b64_tr_b16 a[28:29], v245 offset:24576
    ds_read_b64_tr_b16 a[30:31], v245 offset:25600
    buffer_load_dwordx4 v247, s[20:23], s46 offen offset:1024 lds
    s_waitcnt vmcnt(8) lgkmcnt(0)
    s_barrier
    s_add_u32 m0, s43, 59392
    ds_read_b128 a[208:211], v36 offset:0
    s_add_u32 s47, s46, s61
    s_sub_u32 s15, s47, s62
    s_min_u32 s47, s47, s15
    buffer_load_dwordx4 v246, s[20:23], s47 offen lds
    ds_read_b128 a[212:215], v252 offset:0
    ds_read_b128 a[216:219], v36 offset:2048
    buffer_load_dwordx4 v247, s[20:23], s47 offen offset:1024 lds
    ds_read_b128 a[220:223], v252 offset:2048
    ds_read_b128 a[224:227], v36 offset:4096
    s_add_u32 m0, s43, 67584
    s_add_u32 s46, s47, s61
    s_sub_u32 s15, s46, s62
    s_min_u32 s46, s46, s15
    buffer_load_dwordx4 v246, s[20:23], s46 offen lds
    ds_read_b128 a[228:231], v252 offset:4096
    ds_read_b128 a[232:235], v36 offset:6144
    buffer_load_dwordx4 v247, s[20:23], s46 offen offset:1024 lds
    ds_read_b128 a[236:239], v252 offset:6144
    ds_read_b64_tr_b16 a[32:33], v244 offset:32768
    s_add_u32 m0, s43, 145408
    s_add_u32 s47, s46, s61
    s_sub_u32 s15, s47, s62
    s_min_u32 s47, s47, s15
    buffer_load_dwordx4 v246, s[20:23], s47 offen lds
    ds_read_b64_tr_b16 a[34:35], v244 offset:33792
    ds_read_b64_tr_b16 a[36:37], v245 offset:32768
    buffer_load_dwordx4 v247, s[20:23], s47 offen offset:1024 lds
    ds_read_b64_tr_b16 a[38:39], v245 offset:33792
    ds_read_b64_tr_b16 a[40:41], v244 offset:40960
    s_add_u32 m0, s43, 153600
    s_add_u32 s46, s47, s61
    s_sub_u32 s15, s46, s62
    s_min_u32 s46, s46, s15
    buffer_load_dwordx4 v246, s[20:23], s46 offen lds
    ds_read_b64_tr_b16 a[42:43], v244 offset:41984
    ds_read_b64_tr_b16 a[44:45], v245 offset:40960
    buffer_load_dwordx4 v247, s[20:23], s46 offen offset:1024 lds
    ds_read_b64_tr_b16 a[46:47], v245 offset:41984
    ds_read_b64_tr_b16 a[48:49], v244 offset:49152
    ds_read_b64_tr_b16 a[50:51], v244 offset:50176
    ds_read_b64_tr_b16 a[52:53], v245 offset:49152
    ds_read_b64_tr_b16 a[54:55], v245 offset:50176
    ds_read_b64_tr_b16 a[56:57], v244 offset:57344
    ds_read_b64_tr_b16 a[58:59], v244 offset:58368
    ds_read_b64_tr_b16 a[60:61], v245 offset:57344
    ds_read_b64_tr_b16 a[62:63], v245 offset:58368
    s_waitcnt vmcnt(8) lgkmcnt(0)
    s_barrier
    s_add_u32 m0, s43, 79872
    v_mfma_f32_16x16x32_bf16 v[0:3], a[0:3], a[208:211], v[16:19]
    s_add_u32 s47, s46, s61
    v_subrev_u32 v244, 53248, v244
    v_subrev_u32 v245, 53248, v245
    v_mfma_f32_16x16x32_bf16 v[0:3], a[8:11], a[212:215], v[0:3]
    s_sub_u32 s15, s47, s62
    ds_read_b64_tr_b16 a[64:65], v244 offset:0
    ds_read_b64_tr_b16 a[66:67], v244 offset:1024
    v_mfma_f32_16x16x32_bf16 v[4:7], a[4:7], a[208:211], v[20:23]
    s_min_u32 s47, s47, s15
    ds_read_b128 a[208:211], v36 offset:8192
    ds_read_b64_tr_b16 a[68:69], v245 offset:0
    v_mfma_f32_16x16x32_bf16 v[4:7], a[12:15], a[212:215], v[4:7]
    s_nop 0
    ds_read_b128 a[212:215], v252 offset:8192
    ds_read_b64_tr_b16 a[70:71], v245 offset:1024
    v_mfma_f32_16x16x32_bf16 v[0:3], a[16:19], a[216:219], v[0:3]
    buffer_load_dwordx4 v246, s[20:23], s47 offen lds
    v_mfma_f32_16x16x32_bf16 v[0:3], a[24:27], a[220:223], v[0:3]
    buffer_load_dwordx4 v247, s[20:23], s47 offen offset:1024 lds
    v_mfma_f32_16x16x32_bf16 v[4:7], a[20:23], a[216:219], v[4:7]
    s_add_u32 m0, s43, 88064
    ds_read_b128 a[216:219], v36 offset:10240
    ds_read_b64_tr_b16 a[72:73], v244 offset:8192
    v_mfma_f32_16x16x32_bf16 v[4:7], a[28:31], a[220:223], v[4:7]
    s_add_u32 s46, s47, s61
    ds_read_b128 a[220:223], v252 offset:10240
    ds_read_b64_tr_b16 a[74:75], v244 offset:9216
    s_sub_u32 s15, s46, s62
    s_min_u32 s46, s46, s15
    buffer_load_dwordx4 v246, s[20:23], s46 offen lds
    ds_read_b64_tr_b16 a[76:77], v245 offset:8192
    ds_read_b64_tr_b16 a[78:79], v245 offset:9216
    buffer_load_dwordx4 v247, s[20:23], s46 offen offset:1024 lds
    ds_read_b64_tr_b16 a[80:81], v244 offset:16384
    ds_read_b64_tr_b16 a[82:83], v244 offset:17408
    s_add_u32 m0, s43, 96256
    s_add_u32 s47, s46, s61
    s_sub_u32 s15, s47, s62
    s_min_u32 s47, s47, s15
    buffer_load_dwordx4 v246, s[20:23], s47 offen lds
    ds_read_b64_tr_b16 a[84:85], v245 offset:16384
    ds_read_b64_tr_b16 a[86:87], v245 offset:17408
    buffer_load_dwordx4 v247, s[20:23], s47 offen offset:1024 lds
    ds_read_b64_tr_b16 a[88:89], v244 offset:24576
    ds_read_b64_tr_b16 a[90:91], v244 offset:25600
    s_add_u32 m0, s43, 104448
    s_add_u32 s46, s47, s61
    s_sub_u32 s15, s46, s62
    s_min_u32 s46, s46, s15
    buffer_load_dwordx4 v246, s[20:23], s46 offen lds
    ds_read_b64_tr_b16 a[92:93], v245 offset:24576
    ds_read_b64_tr_b16 a[94:95], v245 offset:25600
    buffer_load_dwordx4 v247, s[20:23], s46 offen offset:1024 lds
    s_waitcnt vmcnt(8) lgkmcnt(0)
    s_barrier
    s_add_u32 m0, s43, 112640
    ds_read_b64_tr_b16 a[96:97], v244 offset:32768
    ds_read_b64_tr_b16 a[98:99], v244 offset:33792
    v_mfma_f32_16x16x32_bf16 v[0:3], a[32:35], a[224:227], v[0:3]
    s_add_u32 s47, s46, s61
    ds_read_b64_tr_b16 a[100:101], v245 offset:32768
    ds_read_b64_tr_b16 a[102:103], v245 offset:33792
    v_mfma_f32_16x16x32_bf16 v[0:3], a[40:43], a[228:231], v[0:3]
    s_sub_u32 s15, s47, s62
    ds_read_b64_tr_b16 a[104:105], v244 offset:40960
    ds_read_b64_tr_b16 a[106:107], v244 offset:41984
    v_mfma_f32_16x16x32_bf16 v[4:7], a[36:39], a[224:227], v[4:7]
    s_min_u32 s47, s47, s15
    ds_read_b128 a[224:227], v36 offset:12288
    ds_read_b64_tr_b16 a[108:109], v245 offset:40960
    v_mfma_f32_16x16x32_bf16 v[4:7], a[44:47], a[228:231], v[4:7]
    s_nop 0
    ds_read_b128 a[228:231], v252 offset:12288
    ds_read_b64_tr_b16 a[110:111], v245 offset:41984
    v_mfma_f32_16x16x32_bf16 v[0:3], a[48:51], a[232:235], v[0:3]
    buffer_load_dwordx4 v246, s[20:23], s47 offen lds
    v_mfma_f32_16x16x32_bf16 v[0:3], a[56:59], a[236:239], v[0:3]
    buffer_load_dwordx4 v247, s[20:23], s47 offen offset:1024 lds
    v_mfma_f32_16x16x32_bf16 v[4:7], a[52:55], a[232:235], v[4:7]
    s_add_u32 m0, s43, 120832
    ds_read_b128 a[232:235], v36 offset:14336
    v_add_u32 v244, 118784, v244
    v_mfma_f32_16x16x32_bf16 v[4:7], a[60:63], a[236:239], v[4:7]
    s_add_u32 s46, s47, s61
    ds_read_b128 a[236:239], v252 offset:14336
    v_add_u32 v245, 118784, v245
    s_sub_u32 s15, s46, s62
    s_min_u32 s46, s46, s15
    buffer_load_dwordx4 v246, s[20:23], s46 offen lds
    ds_read_b64_tr_b16 a[112:113], v244 offset:0
    ds_read_b64_tr_b16 a[114:115], v244 offset:1024
    buffer_load_dwordx4 v247, s[20:23], s46 offen offset:1024 lds
    ds_read_b64_tr_b16 a[116:117], v245 offset:0
    ds_read_b64_tr_b16 a[118:119], v245 offset:1024
    s_add_u32 m0, s43, 129024
    s_add_u32 s47, s46, s61
    s_sub_u32 s15, s47, s62
    s_min_u32 s47, s47, s15
    buffer_load_dwordx4 v246, s[20:23], s47 offen lds
    ds_read_b64_tr_b16 a[120:121], v244 offset:8192
    ds_read_b64_tr_b16 a[122:123], v244 offset:9216
    buffer_load_dwordx4 v247, s[20:23], s47 offen offset:1024 lds
    ds_read_b64_tr_b16 a[124:125], v245 offset:8192
    ds_read_b64_tr_b16 a[126:127], v245 offset:9216
    s_add_u32 m0, s43, 137216
    s_add_u32 s46, s47, s61
    s_sub_u32 s15, s46, s62
    s_min_u32 s46, s46, s15
    buffer_load_dwordx4 v246, s[20:23], s46 offen lds
    buffer_load_dwordx4 v247, s[20:23], s46 offen offset:1024 lds
    buffer_load_dwordx2 v[32:33], v11, s[36:39], 0 offen sc1
    s_waitcnt vmcnt(9) lgkmcnt(0)
    s_barrier
    s_add_u32 m0, s43, 145408
    v_mfma_f32_16x16x32_bf16 v[0:3], a[64:67], a[208:211], v[0:3]
    s_add_u32 s47, s46, s61
    v_subrev_u32 v244, 65536, v244
    v_subrev_u32 v245, 65536, v245
    v_mfma_f32_16x16x32_bf16 v[0:3], a[72:75], a[212:215], v[0:3]
    s_sub_u32 s15, s47, s62
    ds_read_b64_tr_b16 a[128:129], v244 offset:0
    ds_read_b64_tr_b16 a[130:131], v244 offset:1024
    v_mfma_f32_16x16x32_bf16 v[4:7], a[68:71], a[208:211], v[4:7]
    s_min_u32 s47, s47, s15
    ds_read_b128 a[208:211], v36 offset:16384
    ds_read_b64_tr_b16 a[132:133], v245 offset:0
    v_mfma_f32_16x16x32_bf16 v[4:7], a[76:79], a[212:215], v[4:7]
    s_nop 0
    ds_read_b128 a[212:215], v252 offset:16384
    ds_read_b64_tr_b16 a[134:135], v245 offset:1024
    v_mfma_f32_16x16x32_bf16 v[0:3], a[80:83], a[216:219], v[0:3]
    buffer_load_dwordx4 v246, s[20:23], s47 offen lds
    v_mfma_f32_16x16x32_bf16 v[0:3], a[88:91], a[220:223], v[0:3]
    buffer_load_dwordx4 v247, s[20:23], s47 offen offset:1024 lds
    v_mfma_f32_16x16x32_bf16 v[4:7], a[84:87], a[216:219], v[4:7]
    s_add_u32 m0, s43, 153600
    ds_read_b128 a[216:219], v36 offset:18432
    ds_read_b64_tr_b16 a[136:137], v244 offset:8192
    v_mfma_f32_16x16x32_bf16 v[4:7], a[92:95], a[220:223], v[4:7]
    s_add_u32 s46, s47, s61
    ds_read_b128 a[220:223], v252 offset:18432
    ds_read_b64_tr_b16 a[138:139], v244 offset:9216
    s_sub_u32 s15, s46, s62
    s_min_u32 s46, s46, s15
    buffer_load_dwordx4 v246, s[20:23], s46 offen lds
    ds_read_b64_tr_b16 a[140:141], v245 offset:8192
    ds_read_b64_tr_b16 a[142:143], v245 offset:9216
    buffer_load_dwordx4 v247, s[20:23], s46 offen offset:1024 lds
    ds_read_b64_tr_b16 a[144:145], v244 offset:16384
    ds_read_b64_tr_b16 a[146:147], v244 offset:17408
    s_mov_b32 m0, s68
    s_add_u32 s4, s4, s63
    buffer_load_dwordx4 v42, s[16:19], s4 offen offset:0 lds
    ds_read_b64_tr_b16 a[148:149], v245 offset:16384
    ds_read_b64_tr_b16 a[150:151], v245 offset:17408
L_page1:
    s_cbranch_execz L_page5
    s_add_u32 s5, s5, s63
    buffer_load_dwordx4 v253, s[16:19], s5 offen offset:1024 lds
    ds_read_b64_tr_b16 a[152:153], v244 offset:24576
    ds_read_b64_tr_b16 a[154:155], v244 offset:25600
    s_add_u32 s6, s6, s63
    buffer_load_dwordx4 v42, s[16:19], s6 offen offset:2048 lds
    ds_read_b64_tr_b16 a[156:157], v245 offset:24576
    ds_read_b64_tr_b16 a[158:159], v245 offset:25600
    s_add_u32 s7, s7, s63
    buffer_load_dwordx4 v253, s[16:19], s7 offen offset:3072 lds
    s_addk_i32 m0, 4096
    s_add_u32 s8, s8, s63
    buffer_load_dwordx4 v42, s[16:19], s8 offen offset:0 lds
    s_add_u32 s9, s9, s63
    buffer_load_dwordx4 v253, s[16:19], s9 offen offset:1024 lds
    s_mov_b32 m0, s33
    s_add_u32 s10, s10, s63
    buffer_load_dwordx4 v42, s[16:19], s10 offen offset:0 lds
    s_waitcnt vmcnt(12) lgkmcnt(0)
    s_barrier
    s_mov_b32 m0, s69
    ds_read_b64_tr_b16 a[160:161], v244 offset:32768
    ds_read_b64_tr_b16 a[162:163], v244 offset:33792
    v_mfma_f32_16x16x32_bf16 v[0:3], a[96:99], a[224:227], v[0:3]
    s_add_u32 s4, s4, s63
    ds_read_b64_tr_b16 a[164:165], v245 offset:32768
    ds_read_b64_tr_b16 a[166:167], v245 offset:33792
    v_mfma_f32_16x16x32_bf16 v[0:3], a[104:107], a[228:231], v[0:3]
    buffer_load_dwordx4 v42, s[16:19], s4 offen offset:0 lds
    v_mfma_f32_16x16x32_bf16 v[4:7], a[100:103], a[224:227], v[4:7]
    s_add_u32 s5, s5, s63
    ds_read_b128 a[224:227], v36 offset:20480
    ds_read_b64_tr_b16 a[168:169], v244 offset:40960
    v_mfma_f32_16x16x32_bf16 v[4:7], a[108:111], a[228:231], v[4:7]
    s_nop 0
    ds_read_b128 a[228:231], v252 offset:20480
    ds_read_b64_tr_b16 a[170:171], v244 offset:41984
    v_mfma_f32_16x16x32_bf16 v[0:3], a[112:115], a[232:235], v[0:3]
    buffer_load_dwordx4 v253, s[16:19], s5 offen offset:1024 lds
    v_mfma_f32_16x16x32_bf16 v[0:3], a[120:123], a[236:239], v[0:3]
    s_add_u32 s6, s6, s63
    ds_read_b64_tr_b16 a[172:173], v245 offset:40960
    ds_read_b64_tr_b16 a[174:175], v245 offset:41984
    v_mfma_f32_16x16x32_bf16 v[4:7], a[116:119], a[232:235], v[4:7]
    s_nop 0
    ds_read_b128 a[232:235], v36 offset:22528
    ds_read_b64_tr_b16 a[176:177], v244 offset:49152
    v_mfma_f32_16x16x32_bf16 v[4:7], a[124:127], a[236:239], v[4:7]
    s_nop 0
    ds_read_b128 a[236:239], v252 offset:22528
    ds_read_b64_tr_b16 a[178:179], v244 offset:50176
    buffer_load_dwordx4 v42, s[16:19], s6 offen offset:2048 lds
    ds_read_b64_tr_b16 a[180:181], v245 offset:49152
    ds_read_b64_tr_b16 a[182:183], v245 offset:50176
    s_add_u32 s7, s7, s63
    buffer_load_dwordx4 v253, s[16:19], s7 offen offset:3072 lds
    ds_read_b64_tr_b16 a[184:185], v244 offset:57344
    ds_read_b64_tr_b16 a[186:187], v244 offset:58368
    s_addk_i32 m0, 4096
    s_add_u32 s8, s8, s63
    buffer_load_dwordx4 v42, s[16:19], s8 offen offset:0 lds
    ds_read_b64_tr_b16 a[188:189], v245 offset:57344
    ds_read_b64_tr_b16 a[190:191], v245 offset:58368
    s_add_u32 s9, s9, s63
    buffer_load_dwordx4 v253, s[16:19], s9 offen offset:1024 lds
    s_mov_b32 m0, s34
    s_add_u32 s10, s10, s63
    buffer_load_dwordx4 v42, s[16:19], s10 offen offset:0 lds
    s_mov_b32 m0, s65
    s_add_u32 s20, s20, 1384448
    s_addc_u32 s21, s21, 0
    s_mov_b32 s22, 2768896
    s_mov_b32 s47, 0
    buffer_load_dwordx4 v40, s[20:23], s47 offen lds
    buffer_load_dwordx4 v41, s[20:23], s47 offen offset:1024 lds
    s_addk_i32 m0, 8192
    s_add_u32 s46, s47, s61
    buffer_load_dwordx4 v40, s[20:23], s46 offen lds
    buffer_load_dwordx4 v41, s[20:23], s46 offen offset:1024 lds
    s_addk_i32 m0, 8192
    s_add_u32 s47, s46, s61
    buffer_load_dwordx4 v40, s[20:23], s47 offen lds
    buffer_load_dwordx4 v41, s[20:23], s47 offen offset:1024 lds
    s_addk_i32 m0, 8192
    s_add_u32 s46, s47, s61
    buffer_load_dwordx4 v40, s[20:23], s46 offen lds
    buffer_load_dwordx4 v41, s[20:23], s46 offen offset:1024 lds
    s_waitcnt vmcnt(22) lgkmcnt(0)
    s_barrier
    s_mov_b32 m0, s66
    v_mfma_f32_16x16x32_bf16 v[0:3], a[128:131], a[208:211], v[0:3]
    s_add_u32 s47, s46, s61
    v_add_u32 v244, 65536, v244
    v_add_u32 v245, 65536, v245
    v_mfma_f32_16x16x32_bf16 v[0:3], a[136:139], a[212:215], v[0:3]
    buffer_load_dwordx4 v40, s[20:23], s47 offen lds
    v_mfma_f32_16x16x32_bf16 v[4:7], a[132:135], a[208:211], v[4:7]
    s_nop 0
    ds_read_b128 a[208:211], v36 offset:24576
    ds_read_b64_tr_b16 a[192:193], v244 offset:0
    v_mfma_f32_16x16x32_bf16 v[4:7], a[140:143], a[212:215], v[4:7]
    ds_read_b128 a[212:215], v252 offset:24576
    v_add_u32 v36, 26624, v36
    v_mfma_f32_16x16x32_bf16 v[0:3], a[144:147], a[216:219], v[0:3]
    buffer_load_dwordx4 v41, s[20:23], s47 offen offset:1024 lds
    v_mfma_f32_16x16x32_bf16 v[0:3], a[152:155], a[220:223], v[0:3]
    s_addk_i32 m0, 8192
    ds_read_b64_tr_b16 a[194:195], v244 offset:1024
    ds_read_b64_tr_b16 a[196:197], v245 offset:0
    v_mfma_f32_16x16x32_bf16 v[4:7], a[148:151], a[216:219], v[4:7]
    s_add_u32 s46, s47, s61
    ds_read_b64_tr_b16 a[198:199], v245 offset:1024
    ds_read_b64_tr_b16 a[200:201], v244 offset:8192
    v_mfma_f32_16x16x32_bf16 v[4:7], a[156:159], a[220:223], v[4:7]
    buffer_load_dwordx4 v40, s[20:23], s46 offen lds
    buffer_load_dwordx4 v41, s[20:23], s46 offen offset:1024 lds
    ds_read_b64_tr_b16 a[202:203], v244 offset:9216
    ds_read_b64_tr_b16 a[204:205], v245 offset:8192
    s_addk_i32 m0, 8192
    s_add_u32 s47, s46, s61
    buffer_load_dwordx4 v40, s[20:23], s47 offen lds
    ds_read_b64_tr_b16 a[206:207], v245 offset:9216
    v_add_u32 v252, 26624, v252
    buffer_load_dwordx4 v41, s[20:23], s47 offen offset:1024 lds
    ds_read_b64 v[28:29], v254 offset:0
    ds_read_b64 v[30:31], v255 offset:0
    s_addk_i32 m0, 8192
    s_add_u32 s46, s47, s61
    buffer_load_dwordx4 v40, s[20:23], s46 offen lds
    buffer_load_dwordx4 v41, s[20:23], s46 offen offset:1024 lds
    s_waitcnt vmcnt(8) lgkmcnt(0)
    s_barrier
    v_mfma_f32_16x16x32_bf16 v[0:3], a[160:163], a[224:227], v[0:3]
    s_mov_b32 m0, s67
    ds_read_b128 a[216:219], v36 offset:0
    ds_read_b64_tr_b16 v[48:49], v38 offset:0
    v_mfma_f32_16x16x32_bf16 v[0:3], a[168:171], a[228:231], v[0:3]
    s_add_u32 s4, s4, s63
    ds_read_b128 a[220:223], v252 offset:0
    ds_read_b64_tr_b16 v[50:51], v38 offset:4096
    v_mfma_f32_16x16x32_bf16 v[4:7], a[164:167], a[224:227], v[4:7]
    s_add_u32 s5, s5, s63
    ds_read_b128 a[224:227], v36 offset:2048
    ds_read_b64_tr_b16 v[52:53], v39 offset:0
    v_mfma_f32_16x16x32_bf16 v[4:7], a[172:175], a[228:231], v[4:7]
    s_add_u32 s52, s40, 133120
    ds_read_b128 a[228:231], v252 offset:2048
    ds_read_b64_tr_b16 v[54:55], v39 offset:4096
    v_mfma_f32_16x16x32_bf16 v[0:3], a[176:179], a[232:235], v[0:3]
    buffer_load_dwordx4 v42, s[16:19], s4 offen offset:0 lds
    v_mfma_f32_16x16x32_bf16 v[0:3], a[184:187], a[236:239], v[0:3]
    buffer_load_dword v47, v251, s[16:19], s52 offen
    v_mfma_f32_16x16x32_bf16 v[4:7], a[180:183], a[232:235], v[4:7]
    s_add_u32 s6, s6, s63
    ds_read_b128 a[232:235], v36 offset:4096
    ds_read_b64_tr_b16 v[56:57], v38 offset:8192
    v_mfma_f32_16x16x32_bf16 v[4:7], a[188:191], a[236:239], v[4:7]
    s_add_u32 s1, s1, s63
    ds_read_b128 a[236:239], v252 offset:4096
    ds_read_b64_tr_b16 v[58:59], v38 offset:12288
    v_mfma_f32_16x16x32_bf16 v[0:3], a[192:195], a[208:211], v[0:3]
    s_nop 0
    ds_read_b64_tr_b16 v[60:61], v39 offset:8192
    ds_read_b64_tr_b16 v[62:63], v39 offset:12288
    v_mfma_f32_16x16x32_bf16 v[0:3], a[200:203], a[212:215], v[0:3]
    s_nop 0
    ds_read_b64_tr_b16 v[64:65], v38 offset:16384
    ds_read_b64_tr_b16 v[66:67], v38 offset:20480
    v_mfma_f32_16x16x32_bf16 v[4:7], a[196:199], a[208:211], v[4:7]
    s_nop 0
    ds_read_b128 a[208:211], v36 offset:6144
    ds_read_b64_tr_b16 v[68:69], v39 offset:16384
    v_mfma_f32_16x16x32_bf16 v[4:7], a[204:207], a[212:215], v[4:7]
    s_waitcnt lgkmcnt(15)
    ds_read_b128 a[212:215], v252 offset:6144
    ds_read_b64_tr_b16 v[70:71], v39 offset:20480
    v_mfma_f32_16x16x32_bf16 v[8:11], a[0:3], a[216:219], v[16:19]
    buffer_load_dwordx4 v253, s[16:19], s5 offen offset:1024 lds
    v_mfma_f32_16x16x32_bf16 v[8:11], a[8:11], a[220:223], v[8:11]
    s_nop 0
    ds_read_b64_tr_b16 v[72:73], v38 offset:24576
    ds_read_b64_tr_b16 v[74:75], v38 offset:28672
    v_mfma_f32_16x16x32_bf16 v[12:15], a[4:7], a[216:219], v[20:23]
    s_add_u32 s7, s7, s63
    ds_read_b128 a[216:219], v36 offset:8192
    ds_read_b64_tr_b16 v[76:77], v39 offset:24576
    v_mfma_f32_16x16x32_bf16 v[12:15], a[12:15], a[220:223], v[12:15]
    s_waitcnt lgkmcnt(15)
    ds_read_b128 a[220:223], v252 offset:8192
    ds_read_b64_tr_b16 v[78:79], v39 offset:28672
    v_mfma_f32_16x16x32_bf16 v[8:11], a[16:19], a[224:227], v[8:11]
    v_cmp_eq_u32 vcc, 0, v33
    s_cbranch_vccnz L_slow_nonce
L_back_nonce:
    v_mfma_f32_16x16x32_bf16 v[8:11], a[24:27], a[228:231], v[8:11]
    v_readfirstlane_b32 s45, v32
    v_mov_b32 v37, v32
    v_mfma_f32_16x16x32_bf16 v[12:15], a[20:23], a[224:227], v[12:15]
    s_nop 0
    ds_read_b128 a[224:227], v36 offset:10240
    ds_write_b128 v43, v[28:31] offset:0
    v_mfma_f32_16x16x32_bf16 v[12:15], a[28:31], a[228:231], v[12:15]
    s_waitcnt lgkmcnt(15)
    ds_read_b128 a[228:231], v252 offset:10240
    v_lshlrev_b32 v32, 16, v28
    v_mfma_f32_16x16x32_bf16 v[8:11], a[32:35], a[232:235], v[8:11]
    buffer_load_dwordx4 v42, s[16:19], s6 offen offset:2048 lds
    v_mfma_f32_16x16x32_bf16 v[8:11], a[40:43], a[236:239], v[8:11]
    v_and_b32 v33, s60, v28
    v_mul_f32 v32, v32, v0
    v_mfma_f32_16x16x32_bf16 v[12:15], a[36:39], a[232:235], v[12:15]
    ds_read_b128 a[232:235], v36 offset:12288
    v_mul_f32 v33, v33, v1
    v_mfma_f32_16x16x32_bf16 v[12:15], a[44:47], a[236:239], v[12:15]
    s_waitcnt lgkmcnt(11)
    ds_read_b128 a[236:239], v252 offset:12288
    v_cvt_pk_bf16_f32 v24, v32, v33
    v_mfma_f32_16x16x32_bf16 v[8:11], a[48:51], a[208:211], v[8:11]
    s_add_u32 s8, s8, s63
    v_lshlrev_b32 v32, 16, v29
    v_and_b32 v33, s60, v29
    v_mfma_f32_16x16x32_bf16 v[8:11], a[56:59], a[212:215], v[8:11]
    v_mul_f32 v32, v32, v2
    v_mul_f32 v33, v33, v3
    v_mfma_f32_16x16x32_bf16 v[12:15], a[52:55], a[208:211], v[12:15]
    ds_read_b128 a[208:211], v36 offset:14336
    v_cvt_pk_bf16_f32 v25, v32, v33
    v_mfma_f32_16x16x32_bf16 v[12:15], a[60:63], a[212:215], v[12:15]
    s_waitcnt lgkmcnt(7)
    ds_read_b128 a[212:215], v252 offset:14336
    v_lshlrev_b32 v32, 16, v30
    v_mfma_f32_16x16x32_bf16 v[8:11], a[64:67], a[216:219], v[8:11]
    buffer_load_dwordx4 v253, s[16:19], s7 offen offset:3072 lds
    v_mfma_f32_16x16x32_bf16 v[8:11], a[72:75], a[220:223], v[8:11]
    s_addk_i32 m0, 4096
    v_and_b32 v33, s60, v30
    v_mul_f32 v32, v32, v4
    v_mfma_f32_16x16x32_bf16 v[12:15], a[68:71], a[216:219], v[12:15]
    ds_read_b128 a[216:219], v36 offset:16384
    v_mul_f32 v33, v33, v5
    v_mfma_f32_16x16x32_bf16 v[12:15], a[76:79], a[220:223], v[12:15]
    s_waitcnt lgkmcnt(5)
    ds_read_b128 a[220:223], v252 offset:16384
    v_cvt_pk_bf16_f32 v26, v32, v33
    v_mfma_f32_16x16x32_bf16 v[8:11], a[80:83], a[224:227], v[8:11]
    s_add_u32 s9, s9, s63
    v_lshlrev_b32 v32, 16, v31
    v_and_b32 v33, s60, v31
    v_mfma_f32_16x16x32_bf16 v[8:11], a[88:91], a[228:231], v[8:11]
    s_nop 0
    ds_read_b64 v[28:29], v254 offset:26624
    ds_read_b64 v[30:31], v255 offset:26624
    v_mfma_f32_16x16x32_bf16 v[12:15], a[84:87], a[224:227], v[12:15]
    ds_read_b128 a[224:227], v36 offset:18432
    v_mul_f32 v32, v32, v6
    v_mfma_f32_16x16x32_bf16 v[12:15], a[92:95], a[228:231], v[12:15]
    s_waitcnt lgkmcnt(7)
    ds_read_b128 a[228:231], v252 offset:18432
    v_mul_f32 v33, v33, v7
    v_mfma_f32_16x16x32_bf16 v[8:11], a[96:99], a[232:235], v[8:11]
    v_cvt_pk_bf16_f32 v27, v32, v33
    v_mfma_f32_16x16x32_bf16 v[8:11], a[104:107], a[236:239], v[8:11]
    buffer_load_dwordx4 v42, s[16:19], s8 offen offset:0 lds
    v_mfma_f32_16x16x32_bf16 v[12:15], a[100:103], a[232:235], v[12:15]
    ds_read_b128 a[232:235], v36 offset:20480
    v_mfma_f32_16x16x32_bf16 v[12:15], a[108:111], a[236:239], v[12:15]
    s_waitcnt lgkmcnt(7)
    ds_read_b128 a[236:239], v252 offset:20480
    v_mfma_f32_16x16x32_bf16 v[8:11], a[112:115], a[208:211], v[8:11]
    buffer_store_dwordx4 v[24:27], v44, s[24:27], s1 offen sc1
    v_mfma_f32_16x16x32_bf16 v[8:11], a[120:123], a[212:215], v[8:11]
    s_add_u32 s10, s10, s63
    v_mfma_f32_16x16x32_bf16 v[12:15], a[116:119], a[208:211], v[12:15]
    s_add_u32 s47, s46, s61
    ds_read_b128 a[208:211], v36 offset:22528
    v_mfma_f32_16x16x32_bf16 v[12:15], a[124:127], a[212:215], v[12:15]
    s_waitcnt lgkmcnt(7)
    ds_read_b128 a[212:215], v252 offset:22528
    v_mfma_f32_16x16x32_bf16 v[8:11], a[128:131], a[216:219], v[8:11]
    v_mfma_f32_16x16x32_bf16 v[8:11], a[136:139], a[220:223], v[8:11]
    buffer_load_dwordx4 v253, s[16:19], s9 offen offset:1024 lds
    v_mfma_f32_16x16x32_bf16 v[12:15], a[132:135], a[216:219], v[12:15]
    s_mov_b32 m0, s32
    ds_read_b128 a[216:219], v36 offset:24576
    v_mfma_f32_16x16x32_bf16 v[12:15], a[140:143], a[220:223], v[12:15]
    s_waitcnt lgkmcnt(5)
    ds_read_b128 a[220:223], v252 offset:24576
    v_add_u32 v36, 26624, v36
    v_mfma_f32_16x16x32_bf16 v[8:11], a[144:147], a[224:227], v[8:11]
    v_add_u32 v252, 26624, v252
    v_mfma_f32_16x16x32_bf16 v[8:11], a[152:155], a[228:231], v[8:11]
    v_mfma_f32_16x16x32_bf16 v[12:15], a[148:151], a[224:227], v[12:15]
    v_mfma_f32_16x16x32_bf16 v[12:15], a[156:159], a[228:231], v[12:15]
    s_waitcnt lgkmcnt(4)
    v_mfma_f32_16x16x32_bf16 v[8:11], a[160:163], a[232:235], v[8:11]
    v_mfma_f32_16x16x32_bf16 v[8:11], a[168:171], a[236:239], v[8:11]
    buffer_load_dwordx4 v42, s[16:19], s10 offen offset:0 lds
    s_mov_b32 m0, s65
    s_waitcnt vmcnt(9) lgkmcnt(0)
    s_barrier
    v_mfma_f32_16x16x32_bf16 v[12:15], a[164:167], a[232:235], v[12:15]
    buffer_load_dwordx4 v40, s[20:23], s47 offen lds
    v_mfma_f32_16x16x32_bf16 v[12:15], a[172:175], a[236:239], v[12:15]
    s_add_u32 s46, s47, s61
    ds_read_b128 a[224:227], v36 offset:0
    ds_read_b64_tr_b16 v[80:81], v38 offset:32768
    v_mfma_f32_16x16x32_bf16 v[8:11], a[176:179], a[208:211], v[8:11]
    s_add_u32 s52, s40, 159744
    ds_read_b128 a[228:231], v252 offset:0
    ds_read_b64_tr_b16 v[82:83], v38 offset:36864
    v_mfma_f32_16x16x32_bf16 v[8:11], a[184:187], a[212:215], v[8:11]
    s_addk_i32 s14, 4096
    ds_read_b128 a[232:235], v36 offset:2048
    ds_read_b64_tr_b16 v[84:85], v39 offset:32768
    v_mfma_f32_16x16x32_bf16 v[12:15], a[180:183], a[208:211], v[12:15]
    s_add_u32 s1, s1, s63
    ds_read_b128 a[236:239], v252 offset:2048
    ds_write_b128 v43, v[28:31] offset:4096
    v_mfma_f32_16x16x32_bf16 v[12:15], a[188:191], a[212:215], v[12:15]
    ds_read_b128 a[208:211], v36 offset:4096
    v_lshlrev_b32 v32, 16, v28
    v_mfma_f32_16x16x32_bf16 v[8:11], a[192:195], a[216:219], v[8:11]
    ds_read_b128 a[212:215], v252 offset:4096
    v_and_b32 v33, s60, v28
    v_mfma_f32_16x16x32_bf16 v[8:11], a[200:203], a[220:223], v[8:11]
    buffer_load_dwordx4 v41, s[20:23], s47 offen offset:1024 lds
    v_mfma_f32_16x16x32_bf16 v[12:15], a[196:199], a[216:219], v[12:15]
    s_addk_i32 m0, 8192
    ds_read_b128 a[216:219], v36 offset:6144
    ds_read_b64_tr_b16 v[86:87], v39 offset:36864
    v_mfma_f32_16x16x32_bf16 v[12:15], a[204:207], a[220:223], v[12:15]
    s_waitcnt lgkmcnt(9)
    ds_read_b128 a[220:223], v252 offset:6144
    ds_read_b64_tr_b16 v[88:89], v38 offset:40960
    v_mfma_f32_16x16x32_bf16 v[0:3], a[0:3], a[224:227], v[16:19]
    buffer_load_dwordx4 v40, s[20:23], s46 offen lds
    v_mfma_f32_16x16x32_bf16 v[0:3], a[8:11], a[228:231], v[0:3]
    s_add_u32 s47, s46, s61
    ds_read_b64_tr_b16 v[90:91], v38 offset:45056
    ds_read_b64_tr_b16 v[92:93], v39 offset:40960
    v_mfma_f32_16x16x32_bf16 v[4:7], a[4:7], a[224:227], v[20:23]
    s_add_u32 s4, s4, s63
    ds_read_b128 a[224:227], v36 offset:8192
    v_mul_f32 v32, v32, v8
    v_mfma_f32_16x16x32_bf16 v[4:7], a[12:15], a[228:231], v[4:7]
    s_waitcnt lgkmcnt(10)
    ds_read_b128 a[228:231], v252 offset:8192
    v_mul_f32 v33, v33, v9
    v_mfma_f32_16x16x32_bf16 v[0:3], a[16:19], a[232:235], v[0:3]
    buffer_load_dwordx4 v41, s[20:23], s46 offen offset:1024 lds
    v_mfma_f32_16x16x32_bf16 v[0:3], a[24:27], a[236:239], v[0:3]
    s_addk_i32 m0, 8192
    ds_read_b64_tr_b16 v[94:95], v39 offset:45056
    ds_read_b64_tr_b16 v[96:97], v38 offset:49152
    v_mfma_f32_16x16x32_bf16 v[4:7], a[20:23], a[232:235], v[4:7]
    s_add_u32 s5, s5, s63
    ds_read_b128 a[232:235], v36 offset:10240
    v_cvt_pk_bf16_f32 v24, v32, v33
    v_mfma_f32_16x16x32_bf16 v[4:7], a[28:31], a[236:239], v[4:7]
    s_waitcnt lgkmcnt(11)
    ds_read_b128 a[236:239], v252 offset:10240
    v_lshlrev_b32 v32, 16, v29
    v_mfma_f32_16x16x32_bf16 v[0:3], a[32:35], a[208:211], v[0:3]
    buffer_load_dwordx4 v40, s[20:23], s47 offen lds
    v_mfma_f32_16x16x32_bf16 v[0:3], a[40:43], a[212:215], v[0:3]
    s_nop 0
    ds_read_b64_tr_b16 v[98:99], v38 offset:53248
    ds_read_b64_tr_b16 v[100:101], v39 offset:49152
    v_mfma_f32_16x16x32_bf16 v[4:7], a[36:39], a[208:211], v[4:7]
    s_add_u32 s6, s6, s63
    ds_read_b128 a[208:211], v36 offset:12288
    v_and_b32 v33, s60, v29
    v_mfma_f32_16x16x32_bf16 v[4:7], a[44:47], a[212:215], v[4:7]
    s_waitcnt lgkmcnt(12)
    ds_read_b128 a[212:215], v252 offset:12288
    v_mul_f32 v32, v32, v10
    v_mfma_f32_16x16x32_bf16 v[0:3], a[48:51], a[216:219], v[0:3]
    buffer_load_dwordx4 v41, s[20:23], s47 offen offset:1024 lds
    v_mfma_f32_16x16x32_bf16 v[0:3], a[56:59], a[220:223], v[0:3]
    s_mov_b32 m0, s68
    ds_read_b64_tr_b16 v[102:103], v39 offset:53248
    ds_read_b64_tr_b16 v[104:105], v38 offset:57344
    v_mfma_f32_16x16x32_bf16 v[4:7], a[52:55], a[216:219], v[4:7]
    s_add_u32 s7, s7, s63
    ds_read_b128 a[216:219], v36 offset:14336
    v_mul_f32 v33, v33, v11
    v_mfma_f32_16x16x32_bf16 v[4:7], a[60:63], a[220:223], v[4:7]
    s_waitcnt lgkmcnt(11)
    ds_read_b128 a[220:223], v252 offset:14336
    v_cvt_pk_bf16_f32 v25, v32, v33
    v_mfma_f32_16x16x32_bf16 v[0:3], a[64:67], a[224:227], v[0:3]
    buffer_load_dwordx4 v42, s[16:19], s4 offen offset:0 lds
    v_mfma_f32_16x16x32_bf16 v[0:3], a[72:75], a[228:231], v[0:3]
    buffer_load_dword v47, v251, s[16:19], s52 offen
    v_mfma_f32_16x16x32_bf16 v[4:7], a[68:71], a[224:227], v[4:7]
    s_add_u32 s8, s8, s63
    ds_read_b128 a[224:227], v36 offset:16384
    v_lshlrev_b32 v32, 16, v30
    v_mfma_f32_16x16x32_bf16 v[4:7], a[76:79], a[228:231], v[4:7]
    s_waitcnt lgkmcnt(9)
    ds_read_b128 a[228:231], v252 offset:16384
    v_and_b32 v33, s60, v30
    v_mfma_f32_16x16x32_bf16 v[0:3], a[80:83], a[232:235], v[0:3]
    buffer_load_dwordx4 v253, s[16:19], s5 offen offset:1024 lds
    v_mfma_f32_16x16x32_bf16 v[0:3], a[88:91], a[236:239], v[0:3]
    s_nop 0
    ds_read_b64_tr_b16 v[106:107], v38 offset:61440
    ds_read_b64_tr_b16 v[108:109], v39 offset:57344
    v_mfma_f32_16x16x32_bf16 v[4:7], a[84:87], a[232:235], v[4:7]
    ds_read_b128 a[232:235], v36 offset:18432
    v_mul_f32 v32, v32, v12
    v_mfma_f32_16x16x32_bf16 v[4:7], a[92:95], a[236:239], v[4:7]
    s_waitcnt lgkmcnt(9)
    ds_read_b128 a[236:239], v252 offset:18432
    v_mul_f32 v33, v33, v13
    v_mfma_f32_16x16x32_bf16 v[0:3], a[96:99], a[208:211], v[0:3]
    buffer_load_dwordx4 v42, s[16:19], s6 offen offset:2048 lds
    v_mfma_f32_16x16x32_bf16 v[0:3], a[104:107], a[212:215], v[0:3]
    s_add_u32 s9, s9, s63
    ds_read_b64_tr_b16 v[110:111], v39 offset:61440
    v_cvt_pk_bf16_f32 v26, v32, v33
    v_mfma_f32_16x16x32_bf16 v[4:7], a[100:103], a[208:211], v[4:7]
    ds_read_b128 a[208:211], v36 offset:20480
    v_lshlrev_b32 v32, 16, v31
    v_mfma_f32_16x16x32_bf16 v[4:7], a[108:111], a[212:215], v[4:7]
    s_waitcnt lgkmcnt(8)
    ds_read_b128 a[212:215], v252 offset:20480
    v_and_b32 v33, s60, v31
    v_mfma_f32_16x16x32_bf16 v[0:3], a[112:115], a[216:219], v[0:3]
    buffer_load_dwordx4 v253, s[16:19], s7 offen offset:3072 lds
    v_mfma_f32_16x16x32_bf16 v[0:3], a[120:123], a[220:223], v[0:3]
    s_addk_i32 m0, 4096
    ds_read_b64 v[28:29], v254 offset:53248
    ds_read_b64 v[30:31], v255 offset:53248
    v_mfma_f32_16x16x32_bf16 v[4:7], a[116:119], a[216:219], v[4:7]
    s_add_u32 s10, s10, s63
    ds_read_b128 a[216:219], v36 offset:22528
    v_mul_f32 v32, v32, v14
    v_mfma_f32_16x16x32_bf16 v[4:7], a[124:127], a[220:223], v[4:7]
    s_waitcnt lgkmcnt(10)
    ds_read_b128 a[220:223], v252 offset:22528
    v_mul_f32 v33, v33, v15
    v_mfma_f32_16x16x32_bf16 v[0:3], a[128:131], a[224:227], v[0:3]
    buffer_load_dwordx4 v42, s[16:19], s8 offen offset:0 lds
    v_mfma_f32_16x16x32_bf16 v[0:3], a[136:139], a[228:231], v[0:3]
    s_add_u32 s46, s47, s61
    v_cvt_pk_bf16_f32 v27, v32, v33
    v_mfma_f32_16x16x32_bf16 v[4:7], a[132:135], a[224:227], v[4:7]
    ds_read_b128 a[224:227], v36 offset:24576
    v_mfma_f32_16x16x32_bf16 v[4:7], a[140:143], a[228:231], v[4:7]
    s_waitcnt lgkmcnt(8)
    ds_read_b128 a[228:231], v252 offset:24576
    v_subrev_u32 v36, 53248, v36
    v_mfma_f32_16x16x32_bf16 v[0:3], a[144:147], a[232:235], v[0:3]
    s_waitcnt vmcnt(14)
    buffer_store_dword v37, v45, s[24:27], s14 offen sc1
    v_mfma_f32_16x16x32_bf16 v[0:3], a[152:155], a[236:239], v[0:3]
    buffer_load_dwordx4 v253, s[16:19], s9 offen offset:1024 lds
    v_mfma_f32_16x16x32_bf16 v[4:7], a[148:151], a[232:235], v[4:7]
    buffer_store_dwordx4 v[24:27], v44, s[24:27], s1 offen sc1
    v_mfma_f32_16x16x32_bf16 v[4:7], a[156:159], a[236:239], v[4:7]
    s_waitcnt lgkmcnt(6)
    s_mov_b32 m0, s33
    v_subrev_u32 v252, 53248, v252
    v_mfma_f32_16x16x32_bf16 v[0:3], a[160:163], a[208:211], v[0:3]
    v_mfma_f32_16x16x32_bf16 v[0:3], a[168:171], a[212:215], v[0:3]
    buffer_load_dwordx4 v42, s[16:19], s10 offen offset:0 lds
    s_mov_b32 m0, s66
    s_waitcnt vmcnt(10) lgkmcnt(0)
    s_barrier
    v_mfma_f32_16x16x32_bf16 v[4:7], a[164:167], a[208:211], v[4:7]
    buffer_load_dwordx4 v40, s[20:23], s46 offen lds
    v_mfma_f32_16x16x32_bf16 v[4:7], a[172:175], a[212:215], v[4:7]
    s_add_u32 s47, s46, s61
    ds_read_b128 a[232:235], v36 offset:0
    ds_read_b64_tr_b16 v[112:113], v38 offset:0
    v_mfma_f32_16x16x32_bf16 v[0:3], a[176:179], a[216:219], v[0:3]
    s_add_u32 s52, s40, 186368
    ds_read_b128 a[236:239], v252 offset:0
    ds_read_b64_tr_b16 v[114:115], v38 offset:4096
    v_mfma_f32_16x16x32_bf16 v[0:3], a[184:187], a[220:223], v[0:3]
    s_addk_i32 s14, 4096
    ds_read_b128 a[208:211], v36 offset:2048
    ds_read_b64_tr_b16 v[116:117], v39 offset:0
    v_mfma_f32_16x16x32_bf16 v[4:7], a[180:183], a[216:219], v[4:7]
    s_add_u32 s1, s1, s63
    ds_read_b128 a[212:215], v252 offset:2048
    ds_write_b128 v43, v[28:31] offset:8192
    v_mfma_f32_16x16x32_bf16 v[4:7], a[188:191], a[220:223], v[4:7]
    ds_read_b128 a[216:219], v36 offset:4096
    v_lshlrev_b32 v32, 16, v28
    v_mfma_f32_16x16x32_bf16 v[0:3], a[192:195], a[224:227], v[0:3]
    ds_read_b128 a[220:223], v252 offset:4096
    v_and_b32 v33, s60, v28
    v_mfma_f32_16x16x32_bf16 v[0:3], a[200:203], a[228:231], v[0:3]
    buffer_load_dwordx4 v41, s[20:23], s46 offen offset:1024 lds
    v_mfma_f32_16x16x32_bf16 v[4:7], a[196:199], a[224:227], v[4:7]
    s_addk_i32 m0, 8192
    ds_read_b128 a[224:227], v36 offset:6144
    ds_read_b64_tr_b16 v[118:119], v39 offset:4096
    v_mfma_f32_16x16x32_bf16 v[4:7], a[204:207], a[228:231], v[4:7]
    s_waitcnt lgkmcnt(9)
    ds_read_b128 a[228:231], v252 offset:6144
    ds_read_b64_tr_b16 v[120:121], v38 offset:8192
    v_mfma_f32_16x16x32_bf16 v[8:11], a[0:3], a[232:235], v[16:19]
    buffer_load_dwordx4 v40, s[20:23], s47 offen lds
    v_mfma_f32_16x16x32_bf16 v[8:11], a[8:11], a[236:239], v[8:11]
    s_add_u32 s46, s47, s61
    ds_read_b64_tr_b16 v[122:123], v38 offset:12288
    ds_read_b64_tr_b16 v[124:125], v39 offset:8192
    v_mfma_f32_16x16x32_bf16 v[12:15], a[4:7], a[232:235], v[20:23]
    s_add_u32 s4, s4, s63
    ds_read_b128 a[232:235], v36 offset:8192
    v_mul_f32 v32, v32, v0
    v_mfma_f32_16x16x32_bf16 v[12:15], a[12:15], a[236:239], v[12:15]
    s_waitcnt lgkmcnt(10)
    ds_read_b128 a[236:239], v252 offset:8192
    v_mul_f32 v33, v33, v1
    v_mfma_f32_16x16x32_bf16 v[8:11], a[16:19], a[208:211], v[8:11]
    buffer_load_dwordx4 v41, s[20:23], s47 offen offset:1024 lds
    v_mfma_f32_16x16x32_bf16 v[8:11], a[24:27], a[212:215], v[8:11]
    s_addk_i32 m0, 8192
    ds_read_b64_tr_b16 v[126:127], v39 offset:12288
    ds_read_b64_tr_b16 v[128:129], v38 offset:16384
    v_mfma_f32_16x16x32_bf16 v[12:15], a[20:23], a[208:211], v[12:15]
    s_add_u32 s5, s5, s63
    ds_read_b128 a[208:211], v36 offset:10240
    v_cvt_pk_bf16_f32 v24, v32, v33
    v_mfma_f32_16x16x32_bf16 v[12:15], a[28:31], a[212:215], v[12:15]
    s_waitcnt lgkmcnt(11)
    ds_read_b128 a[212:215], v252 offset:10240
    v_lshlrev_b32 v32, 16, v29
    v_mfma_f32_16x16x32_bf16 v[8:11], a[32:35], a[216:219], v[8:11]
    buffer_load_dwordx4 v40, s[20:23], s46 offen lds
    v_mfma_f32_16x16x32_bf16 v[8:11], a[40:43], a[220:223], v[8:11]
    s_nop 0
    ds_read_b64_tr_b16 v[130:131], v38 offset:20480
    ds_read_b64_tr_b16 v[132:133], v39 offset:16384
    v_mfma_f32_16x16x32_bf16 v[12:15], a[36:39], a[216:219], v[12:15]
    s_add_u32 s6, s6, s63
    ds_read_b128 a[216:219], v36 offset:12288
    v_and_b32 v33, s60, v29
    v_mfma_f32_16x16x32_bf16 v[12:15], a[44:47], a[220:223], v[12:15]
    s_waitcnt lgkmcnt(12)
    ds_read_b128 a[220:223], v252 offset:12288
    v_mul_f32 v32, v32, v2
    v_mfma_f32_16x16x32_bf16 v[8:11], a[48:51], a[224:227], v[8:11]
    buffer_load_dwordx4 v41, s[20:23], s46 offen offset:1024 lds
    v_mfma_f32_16x16x32_bf16 v[8:11], a[56:59], a[228:231], v[8:11]
    s_mov_b32 m0, s69
    ds_read_b64_tr_b16 v[134:135], v39 offset:20480
    v_mul_f32 v33, v33, v3
    v_mfma_f32_16x16x32_bf16 v[12:15], a[52:55], a[224:227], v[12:15]
    s_add_u32 s7, s7, s63
    ds_read_b128 a[224:227], v36 offset:14336
    v_cvt_pk_bf16_f32 v25, v32, v33
    v_mfma_f32_16x16x32_bf16 v[12:15], a[60:63], a[228:231], v[12:15]
    s_waitcnt lgkmcnt(10)
    ds_read_b128 a[228:231], v252 offset:14336
    v_lshlrev_b32 v32, 16, v30
    v_mfma_f32_16x16x32_bf16 v[8:11], a[64:67], a[232:235], v[8:11]
    buffer_load_dwordx4 v42, s[16:19], s4 offen offset:0 lds
    v_mfma_f32_16x16x32_bf16 v[8:11], a[72:75], a[236:239], v[8:11]
    buffer_load_dword v47, v251, s[16:19], s52 offen
    v_mfma_f32_16x16x32_bf16 v[12:15], a[68:71], a[232:235], v[12:15]
    s_add_u32 s8, s8, s63
    ds_read_b128 a[232:235], v36 offset:16384
    v_and_b32 v33, s60, v30
    v_mfma_f32_16x16x32_bf16 v[12:15], a[76:79], a[236:239], v[12:15]
    s_waitcnt lgkmcnt(8)
    ds_read_b128 a[236:239], v252 offset:16384
    v_mul_f32 v32, v32, v4
    v_mfma_f32_16x16x32_bf16 v[8:11], a[80:83], a[208:211], v[8:11]
    buffer_load_dwordx4 v253, s[16:19], s5 offen offset:1024 lds
    v_mfma_f32_16x16x32_bf16 v[8:11], a[88:91], a[212:215], v[8:11]
    v_mul_f32 v33, v33, v5
    v_cvt_pk_bf16_f32 v26, v32, v33
    v_mfma_f32_16x16x32_bf16 v[12:15], a[84:87], a[208:211], v[12:15]
    ds_read_b128 a[208:211], v36 offset:18432
    v_lshlrev_b32 v32, 16, v31
    v_mfma_f32_16x16x32_bf16 v[12:15], a[92:95], a[212:215], v[12:15]
    s_waitcnt lgkmcnt(6)
    ds_read_b128 a[212:215], v252 offset:18432
    v_and_b32 v33, s60, v31
    v_mfma_f32_16x16x32_bf16 v[8:11], a[96:99], a[216:219], v[8:11]
    buffer_load_dwordx4 v42, s[16:19], s6 offen offset:2048 lds
    v_mfma_f32_16x16x32_bf16 v[8:11], a[104:107], a[220:223], v[8:11]
    s_add_u32 s9, s9, s63
    ds_read_b64 v[28:29], v254 offset:0
    ds_read_b64 v[30:31], v255 offset:0
    v_mfma_f32_16x16x32_bf16 v[12:15], a[100:103], a[216:219], v[12:15]
    ds_read_b128 a[216:219], v36 offset:20480
    v_mul_f32 v32, v32, v6
    v_mfma_f32_16x16x32_bf16 v[12:15], a[108:111], a[220:223], v[12:15]
    s_waitcnt lgkmcnt(7)
    ds_read_b128 a[220:223], v252 offset:20480
    v_mul_f32 v33, v33, v7
    v_mfma_f32_16x16x32_bf16 v[8:11], a[112:115], a[224:227], v[8:11]
    buffer_load_dwordx4 v253, s[16:19], s7 offen offset:3072 lds
    v_mfma_f32_16x16x32_bf16 v[8:11], a[120:123], a[228:231], v[8:11]
    s_addk_i32 m0, 4096
    v_cvt_pk_bf16_f32 v27, v32, v33
    v_mfma_f32_16x16x32_bf16 v[12:15], a[116:119], a[224:227], v[12:15]
    s_add_u32 s10, s10, s63
    ds_read_b128 a[224:227], v36 offset:22528
    v_mfma_f32_16x16x32_bf16 v[12:15], a[124:127], a[228:231], v[12:15]
L_page2:
    s_cbranch_execz L_page6
    s_waitcnt lgkmcnt(7)
    s_add_u32 s47, s46, s61
    ds_read_b128 a[228:231], v252 offset:22528
    v_mfma_f32_16x16x32_bf16 v[8:11], a[128:131], a[232:235], v[8:11]
    buffer_load_dwordx4 v42, s[16:19], s8 offen offset:0 lds
    v_mfma_f32_16x16x32_bf16 v[8:11], a[136:139], a[236:239], v[8:11]
    v_mfma_f32_16x16x32_bf16 v[12:15], a[132:135], a[232:235], v[12:15]
    ds_read_b128 a[232:235], v36 offset:24576
    v_mfma_f32_16x16x32_bf16 v[12:15], a[140:143], a[236:239], v[12:15]
    s_waitcnt lgkmcnt(7)
    ds_read_b128 a[236:239], v252 offset:24576
    v_add_u32 v36, 26624, v36
    v_mfma_f32_16x16x32_bf16 v[8:11], a[144:147], a[208:211], v[8:11]
    s_waitcnt vmcnt(13)
    buffer_store_dword v37, v45, s[24:27], s14 offen sc1
    v_mfma_f32_16x16x32_bf16 v[8:11], a[152:155], a[212:215], v[8:11]
    buffer_load_dwordx4 v253, s[16:19], s9 offen offset:1024 lds
    v_mfma_f32_16x16x32_bf16 v[12:15], a[148:151], a[208:211], v[12:15]
    buffer_store_dwordx4 v[24:27], v44, s[24:27], s1 offen sc1
    v_mfma_f32_16x16x32_bf16 v[12:15], a[156:159], a[212:215], v[12:15]
    s_waitcnt lgkmcnt(4)
    s_mov_b32 m0, s34
    v_add_u32 v252, 26624, v252
    v_mfma_f32_16x16x32_bf16 v[8:11], a[160:163], a[216:219], v[8:11]
    v_mfma_f32_16x16x32_bf16 v[8:11], a[168:171], a[220:223], v[8:11]
    buffer_load_dwordx4 v42, s[16:19], s10 offen offset:0 lds
    s_mov_b32 m0, s65
    s_waitcnt vmcnt(10) lgkmcnt(0)
    s_barrier
    v_mfma_f32_16x16x32_bf16 v[12:15], a[164:167], a[216:219], v[12:15]
    buffer_load_dwordx4 v40, s[20:23], s47 offen lds
    v_mfma_f32_16x16x32_bf16 v[12:15], a[172:175], a[220:223], v[12:15]
    s_add_u32 s46, s47, s61
    ds_read_b128 a[208:211], v36 offset:0
    ds_read_b64_tr_b16 v[136:137], v38 offset:32768
    v_mfma_f32_16x16x32_bf16 v[8:11], a[176:179], a[224:227], v[8:11]
    s_addk_i32 s14, 4096
    ds_read_b128 a[212:215], v252 offset:0
    ds_read_b64_tr_b16 v[138:139], v38 offset:36864
    v_mfma_f32_16x16x32_bf16 v[8:11], a[184:187], a[228:231], v[8:11]
    s_add_u32 s1, s1, s63
    ds_read_b128 a[216:219], v36 offset:2048
    ds_read_b64_tr_b16 v[140:141], v39 offset:32768
    v_mfma_f32_16x16x32_bf16 v[12:15], a[180:183], a[224:227], v[12:15]
    s_nop 0
    ds_read_b128 a[220:223], v252 offset:2048
    ds_write_b128 v43, v[28:31] offset:12288
    v_mfma_f32_16x16x32_bf16 v[12:15], a[188:191], a[228:231], v[12:15]
    ds_read_b128 a[224:227], v36 offset:4096
    v_lshlrev_b32 v32, 16, v28
    v_mfma_f32_16x16x32_bf16 v[8:11], a[192:195], a[232:235], v[8:11]
    ds_read_b128 a[228:231], v252 offset:4096
    v_and_b32 v33, s60, v28
    v_mfma_f32_16x16x32_bf16 v[8:11], a[200:203], a[236:239], v[8:11]
    buffer_load_dwordx4 v41, s[20:23], s47 offen offset:1024 lds
    v_mfma_f32_16x16x32_bf16 v[12:15], a[196:199], a[232:235], v[12:15]
    s_addk_i32 m0, 8192
    ds_read_b128 a[232:235], v36 offset:6144
    ds_read_b64_tr_b16 v[142:143], v39 offset:36864
    v_mfma_f32_16x16x32_bf16 v[12:15], a[204:207], a[236:239], v[12:15]
    s_waitcnt lgkmcnt(9)
    ds_read_b128 a[236:239], v252 offset:6144
    ds_read_b64_tr_b16 v[144:145], v38 offset:40960
    v_mfma_f32_16x16x32_bf16 v[0:3], a[0:3], a[208:211], v[16:19]
    buffer_load_dwordx4 v40, s[20:23], s46 offen lds
    v_mfma_f32_16x16x32_bf16 v[0:3], a[8:11], a[212:215], v[0:3]
    s_add_u32 s47, s46, s61
    ds_read_b64_tr_b16 v[146:147], v38 offset:45056
    ds_read_b64_tr_b16 v[148:149], v39 offset:40960
    v_mfma_f32_16x16x32_bf16 v[4:7], a[4:7], a[208:211], v[20:23]
    s_add_u32 s4, s4, s63
    ds_read_b128 a[208:211], v36 offset:8192
    v_mul_f32 v32, v32, v8
    v_mfma_f32_16x16x32_bf16 v[4:7], a[12:15], a[212:215], v[4:7]
    s_waitcnt lgkmcnt(10)
    ds_read_b128 a[212:215], v252 offset:8192
    v_mul_f32 v33, v33, v9
    v_mfma_f32_16x16x32_bf16 v[0:3], a[16:19], a[216:219], v[0:3]
    buffer_load_dwordx4 v41, s[20:23], s46 offen offset:1024 lds
    v_mfma_f32_16x16x32_bf16 v[0:3], a[24:27], a[220:223], v[0:3]
    s_addk_i32 m0, 8192
    ds_read_b64_tr_b16 v[150:151], v39 offset:45056
    ds_read_b64_tr_b16 v[152:153], v38 offset:49152
    v_mfma_f32_16x16x32_bf16 v[4:7], a[20:23], a[216:219], v[4:7]
    s_add_u32 s5, s5, s63
    ds_read_b128 a[216:219], v36 offset:10240
    v_cvt_pk_bf16_f32 v24, v32, v33
    v_mfma_f32_16x16x32_bf16 v[4:7], a[28:31], a[220:223], v[4:7]
    s_waitcnt lgkmcnt(11)
    ds_read_b128 a[220:223], v252 offset:10240
    v_lshlrev_b32 v32, 16, v29
    v_mfma_f32_16x16x32_bf16 v[0:3], a[32:35], a[224:227], v[0:3]
    buffer_load_dwordx4 v40, s[20:23], s47 offen lds
    v_mfma_f32_16x16x32_bf16 v[0:3], a[40:43], a[228:231], v[0:3]
    s_nop 0
    ds_read_b64_tr_b16 v[154:155], v38 offset:53248
    ds_read_b64_tr_b16 v[156:157], v39 offset:49152
    v_mfma_f32_16x16x32_bf16 v[4:7], a[36:39], a[224:227], v[4:7]
    s_add_u32 s6, s6, s63
    ds_read_b128 a[224:227], v36 offset:12288
    v_and_b32 v33, s60, v29
    v_mfma_f32_16x16x32_bf16 v[4:7], a[44:47], a[228:231], v[4:7]
    s_waitcnt lgkmcnt(12)
    ds_read_b128 a[228:231], v252 offset:12288
    v_mul_f32 v32, v32, v10
    v_mfma_f32_16x16x32_bf16 v[0:3], a[48:51], a[232:235], v[0:3]
    buffer_load_dwordx4 v41, s[20:23], s47 offen offset:1024 lds
    v_mfma_f32_16x16x32_bf16 v[0:3], a[56:59], a[236:239], v[0:3]
    s_mov_b32 m0, s67
    ds_read_b64_tr_b16 v[158:159], v39 offset:53248
    v_mul_f32 v33, v33, v11
    v_mfma_f32_16x16x32_bf16 v[4:7], a[52:55], a[232:235], v[4:7]
    s_add_u32 s7, s7, s63
    ds_read_b128 a[232:235], v36 offset:14336
    v_cvt_pk_bf16_f32 v25, v32, v33
    v_mfma_f32_16x16x32_bf16 v[4:7], a[60:63], a[236:239], v[4:7]
    s_waitcnt lgkmcnt(10)
    ds_read_b128 a[236:239], v252 offset:14336
    v_lshlrev_b32 v32, 16, v30
    v_mfma_f32_16x16x32_bf16 v[0:3], a[64:67], a[208:211], v[0:3]
    buffer_load_dwordx4 v42, s[16:19], s4 offen offset:0 lds
    v_mfma_f32_16x16x32_bf16 v[0:3], a[72:75], a[212:215], v[0:3]
    v_and_b32 v33, s60, v30
    v_mul_f32 v32, v32, v12
    v_mfma_f32_16x16x32_bf16 v[4:7], a[68:71], a[208:211], v[4:7]
    s_add_u32 s8, s8, s63
    ds_read_b128 a[208:211], v36 offset:16384
    v_mul_f32 v33, v33, v13
    v_mfma_f32_16x16x32_bf16 v[4:7], a[76:79], a[212:215], v[4:7]
    s_waitcnt lgkmcnt(8)
    ds_read_b128 a[212:215], v252 offset:16384
    v_cvt_pk_bf16_f32 v26, v32, v33
    v_mfma_f32_16x16x32_bf16 v[0:3], a[80:83], a[216:219], v[0:3]
    buffer_load_dwordx4 v253, s[16:19], s5 offen offset:1024 lds
    v_mfma_f32_16x16x32_bf16 v[0:3], a[88:91], a[220:223], v[0:3]
    v_lshlrev_b32 v32, 16, v31
    v_and_b32 v33, s60, v31
    v_mfma_f32_16x16x32_bf16 v[4:7], a[84:87], a[216:219], v[4:7]
    s_nop 0
    ds_read_b128 a[216:219], v36 offset:18432
    ds_read_b64 v[28:29], v254 offset:26624
    v_mfma_f32_16x16x32_bf16 v[4:7], a[92:95], a[220:223], v[4:7]
    s_waitcnt lgkmcnt(7)
    ds_read_b128 a[220:223], v252 offset:18432
    ds_read_b64 v[30:31], v255 offset:26624
    v_mfma_f32_16x16x32_bf16 v[0:3], a[96:99], a[224:227], v[0:3]
    buffer_load_dwordx4 v42, s[16:19], s6 offen offset:2048 lds
    v_mfma_f32_16x16x32_bf16 v[0:3], a[104:107], a[228:231], v[0:3]
    s_add_u32 s9, s9, s63
    v_mul_f32 v32, v32, v14
    v_mul_f32 v33, v33, v15
    v_mfma_f32_16x16x32_bf16 v[4:7], a[100:103], a[224:227], v[4:7]
    ds_read_b128 a[224:227], v36 offset:20480
    v_cvt_pk_bf16_f32 v27, v32, v33
    v_mfma_f32_16x16x32_bf16 v[4:7], a[108:111], a[228:231], v[4:7]
    s_waitcnt lgkmcnt(7)
    ds_read_b128 a[228:231], v252 offset:20480
    v_mfma_f32_16x16x32_bf16 v[0:3], a[112:115], a[232:235], v[0:3]
    buffer_load_dwordx4 v253, s[16:19], s7 offen offset:3072 lds
    v_mfma_f32_16x16x32_bf16 v[0:3], a[120:123], a[236:239], v[0:3]
    buffer_store_dwordx4 v[24:27], v44, s[24:27], s1 offen sc1
    v_mfma_f32_16x16x32_bf16 v[4:7], a[116:119], a[232:235], v[4:7]
    s_addk_i32 m0, 4096
    ds_read_b128 a[232:235], v36 offset:22528
    v_mfma_f32_16x16x32_bf16 v[4:7], a[124:127], a[236:239], v[4:7]
    s_waitcnt lgkmcnt(7)
    s_add_u32 s10, s10, s63
    ds_read_b128 a[236:239], v252 offset:22528
    v_mfma_f32_16x16x32_bf16 v[0:3], a[128:131], a[208:211], v[0:3]
    buffer_load_dwordx4 v42, s[16:19], s8 offen offset:0 lds
    v_mfma_f32_16x16x32_bf16 v[0:3], a[136:139], a[212:215], v[0:3]
    s_add_u32 s46, s47, s61
    v_mfma_f32_16x16x32_bf16 v[4:7], a[132:135], a[208:211], v[4:7]
    ds_read_b128 a[208:211], v36 offset:24576
    v_mfma_f32_16x16x32_bf16 v[4:7], a[140:143], a[212:215], v[4:7]
    s_waitcnt lgkmcnt(6)
    ds_read_b128 a[212:215], v252 offset:24576
    v_add_u32 v36, 26624, v36
    v_mfma_f32_16x16x32_bf16 v[0:3], a[144:147], a[216:219], v[0:3]
    s_waitcnt vmcnt(13)
    buffer_store_dword v37, v45, s[24:27], s14 offen sc1
    v_mfma_f32_16x16x32_bf16 v[0:3], a[152:155], a[220:223], v[0:3]
    buffer_load_dwordx4 v253, s[16:19], s9 offen offset:1024 lds
    v_mfma_f32_16x16x32_bf16 v[4:7], a[148:151], a[216:219], v[4:7]
    s_mov_b32 m0, s32
    v_add_u32 v252, 26624, v252
    v_mfma_f32_16x16x32_bf16 v[4:7], a[156:159], a[220:223], v[4:7]
    s_waitcnt lgkmcnt(4)
    v_mfma_f32_16x16x32_bf16 v[0:3], a[160:163], a[224:227], v[0:3]
    v_mfma_f32_16x16x32_bf16 v[0:3], a[168:171], a[228:231], v[0:3]
    buffer_load_dwordx4 v42, s[16:19], s10 offen offset:0 lds
    s_mov_b32 m0, s66
    s_waitcnt vmcnt(9) lgkmcnt(0)
    s_barrier
    v_mfma_f32_16x16x32_bf16 v[4:7], a[164:167], a[224:227], v[4:7]
    buffer_load_dwordx4 v40, s[20:23], s46 offen lds
    v_mfma_f32_16x16x32_bf16 v[4:7], a[172:175], a[228:231], v[4:7]
    s_add_u32 s47, s46, s61
    ds_read_b128 a[216:219], v36 offset:0
    v_accvgpr_write_b32 a240, v28
    v_mfma_f32_16x16x32_bf16 v[0:3], a[176:179], a[232:235], v[0:3]
    s_addk_i32 s14, 4096
    ds_read_b128 a[220:223], v252 offset:0
    v_accvgpr_write_b32 a241, v29
    v_mfma_f32_16x16x32_bf16 v[0:3], a[184:187], a[236:239], v[0:3]
    s_add_u32 s1, s1, s63
    ds_read_b128 a[224:227], v36 offset:2048
    v_accvgpr_write_b32 a242, v30
    v_mfma_f32_16x16x32_bf16 v[4:7], a[180:183], a[232:235], v[4:7]
    ds_read_b128 a[228:231], v252 offset:2048
    v_accvgpr_write_b32 a243, v31
    v_mfma_f32_16x16x32_bf16 v[4:7], a[188:191], a[236:239], v[4:7]
    ds_read_b128 a[232:235], v36 offset:4096
    v_lshlrev_b32 v32, 16, v28
    v_mfma_f32_16x16x32_bf16 v[0:3], a[192:195], a[208:211], v[0:3]
    ds_read_b128 a[236:239], v252 offset:4096
    v_and_b32 v33, s60, v28
    v_mfma_f32_16x16x32_bf16 v[0:3], a[200:203], a[212:215], v[0:3]
    buffer_load_dwordx4 v41, s[20:23], s46 offen offset:1024 lds
    v_mfma_f32_16x16x32_bf16 v[4:7], a[196:199], a[208:211], v[4:7]
    s_addk_i32 m0, 8192
    ds_read_b128 a[208:211], v36 offset:6144
    ds_read_b64_tr_b16 v[160:161], v38 offset:0
    v_mfma_f32_16x16x32_bf16 v[4:7], a[204:207], a[212:215], v[4:7]
    s_waitcnt lgkmcnt(6)
    ds_read_b128 a[212:215], v252 offset:6144
    ds_read_b64_tr_b16 v[162:163], v38 offset:4096
    v_mfma_f32_16x16x32_bf16 v[8:11], a[0:3], a[216:219], v[16:19]
    buffer_load_dwordx4 v40, s[20:23], s47 offen lds
    v_mfma_f32_16x16x32_bf16 v[8:11], a[8:11], a[220:223], v[8:11]
    s_add_u32 s46, s47, s61
    ds_read_b64_tr_b16 v[164:165], v39 offset:0
    ds_read_b64_tr_b16 v[166:167], v39 offset:4096
    v_mfma_f32_16x16x32_bf16 v[12:15], a[4:7], a[216:219], v[20:23]
    s_add_u32 s4, s4, s63
    ds_read_b128 a[216:219], v36 offset:8192
    v_mul_f32 v32, v32, v0
    v_mfma_f32_16x16x32_bf16 v[12:15], a[12:15], a[220:223], v[12:15]
    s_waitcnt lgkmcnt(9)
    ds_read_b128 a[220:223], v252 offset:8192
    v_mul_f32 v33, v33, v1
    v_mfma_f32_16x16x32_bf16 v[8:11], a[16:19], a[224:227], v[8:11]
    buffer_load_dwordx4 v41, s[20:23], s47 offen offset:1024 lds
    v_mfma_f32_16x16x32_bf16 v[8:11], a[24:27], a[228:231], v[8:11]
    s_addk_i32 m0, 8192
    ds_read_b64_tr_b16 v[168:169], v38 offset:8192
    ds_read_b64_tr_b16 v[170:171], v38 offset:12288
    v_mfma_f32_16x16x32_bf16 v[12:15], a[20:23], a[224:227], v[12:15]
    s_add_u32 s5, s5, s63
    ds_read_b128 a[224:227], v36 offset:10240
    v_cvt_pk_bf16_f32 v24, v32, v33
    v_mfma_f32_16x16x32_bf16 v[12:15], a[28:31], a[228:231], v[12:15]
    s_waitcnt lgkmcnt(11)
    ds_read_b128 a[228:231], v252 offset:10240
    v_lshlrev_b32 v32, 16, v29
    v_mfma_f32_16x16x32_bf16 v[8:11], a[32:35], a[232:235], v[8:11]
    buffer_load_dwordx4 v40, s[20:23], s46 offen lds
    v_mfma_f32_16x16x32_bf16 v[8:11], a[40:43], a[236:239], v[8:11]
    s_nop 0
    ds_read_b64_tr_b16 v[172:173], v39 offset:8192
    ds_read_b64_tr_b16 v[174:175], v39 offset:12288
    v_mfma_f32_16x16x32_bf16 v[12:15], a[36:39], a[232:235], v[12:15]
    s_add_u32 s6, s6, s63
    ds_read_b128 a[232:235], v36 offset:12288
    v_and_b32 v33, s60, v29
    v_mfma_f32_16x16x32_bf16 v[12:15], a[44:47], a[236:239], v[12:15]
    s_waitcnt lgkmcnt(12)
    ds_read_b128 a[236:239], v252 offset:12288
    v_mul_f32 v32, v32, v2
    v_mfma_f32_16x16x32_bf16 v[8:11], a[48:51], a[208:211], v[8:11]
    buffer_load_dwordx4 v41, s[20:23], s46 offen offset:1024 lds
    v_mfma_f32_16x16x32_bf16 v[8:11], a[56:59], a[212:215], v[8:11]
    s_mov_b32 m0, s68
    ds_read_b64_tr_b16 v[176:177], v38 offset:16384
    ds_read_b64_tr_b16 v[178:179], v38 offset:20480
    v_mfma_f32_16x16x32_bf16 v[12:15], a[52:55], a[208:211], v[12:15]
    s_addk_i32 s49, 4096
    ds_read_b128 a[208:211], v36 offset:14336
    v_mul_f32 v33, v33, v3
    v_mfma_f32_16x16x32_bf16 v[12:15], a[60:63], a[212:215], v[12:15]
    s_waitcnt lgkmcnt(11)
    ds_read_b128 a[212:215], v252 offset:14336
    v_cvt_pk_bf16_f32 v25, v32, v33
    v_mfma_f32_16x16x32_bf16 v[8:11], a[64:67], a[216:219], v[8:11]
    buffer_load_dwordx4 v42, s[16:19], s4 offen offset:0 lds
    v_mfma_f32_16x16x32_bf16 v[8:11], a[72:75], a[220:223], v[8:11]
    s_add_u32 s7, s7, s63
    ds_read_b64_tr_b16 v[180:181], v39 offset:16384
    ds_read_b64_tr_b16 v[182:183], v39 offset:20480
    v_mfma_f32_16x16x32_bf16 v[12:15], a[68:71], a[216:219], v[12:15]
    s_add_u32 s8, s8, s63
    ds_read_b128 a[216:219], v36 offset:16384
    v_lshlrev_b32 v32, 16, v30
    v_mfma_f32_16x16x32_bf16 v[12:15], a[76:79], a[220:223], v[12:15]
    s_waitcnt lgkmcnt(11)
    ds_read_b128 a[220:223], v252 offset:16384
    v_and_b32 v33, s60, v30
    v_mfma_f32_16x16x32_bf16 v[8:11], a[80:83], a[224:227], v[8:11]
    buffer_load_dwordx4 v253, s[16:19], s5 offen offset:1024 lds
    v_mfma_f32_16x16x32_bf16 v[8:11], a[88:91], a[228:231], v[8:11]
    buffer_load_dword v47, v46, s[24:27], s49 offen sc1
    v_mfma_f32_16x16x32_bf16 v[12:15], a[84:87], a[224:227], v[12:15]
    ds_read_b128 a[224:227], v36 offset:18432
    v_mul_f32 v32, v32, v4
    v_mfma_f32_16x16x32_bf16 v[12:15], a[92:95], a[228:231], v[12:15]
    s_waitcnt lgkmcnt(9)
    ds_read_b128 a[228:231], v252 offset:18432
    v_mul_f32 v33, v33, v5
    v_mfma_f32_16x16x32_bf16 v[8:11], a[96:99], a[232:235], v[8:11]
    buffer_load_dwordx4 v42, s[16:19], s6 offen offset:2048 lds
    v_mfma_f32_16x16x32_bf16 v[8:11], a[104:107], a[236:239], v[8:11]
    s_add_u32 s9, s9, s63
    v_cvt_pk_bf16_f32 v26, v32, v33
    v_lshlrev_b32 v32, 16, v31
    v_mfma_f32_16x16x32_bf16 v[12:15], a[100:103], a[232:235], v[12:15]
    ds_read_b128 a[232:235], v36 offset:20480
    v_and_b32 v33, s60, v31
    v_mfma_f32_16x16x32_bf16 v[12:15], a[108:111], a[236:239], v[12:15]
    s_waitcnt lgkmcnt(7)
    ds_read_b128 a[236:239], v252 offset:20480
    ds_read_b64 v[28:29], v254 offset:53248
    v_mfma_f32_16x16x32_bf16 v[8:11], a[112:115], a[208:211], v[8:11]
    buffer_load_dwordx4 v253, s[16:19], s7 offen offset:3072 lds
    v_mfma_f32_16x16x32_bf16 v[8:11], a[120:123], a[212:215], v[8:11]
    s_addk_i32 m0, 4096
    ds_read_b64 v[30:31], v255 offset:53248
    v_mul_f32 v32, v32, v6
    v_mfma_f32_16x16x32_bf16 v[12:15], a[116:119], a[208:211], v[12:15]
    s_add_u32 s10, s10, s63
    ds_read_b128 a[208:211], v36 offset:22528
    v_mul_f32 v33, v33, v7
    v_mfma_f32_16x16x32_bf16 v[12:15], a[124:127], a[212:215], v[12:15]
    s_waitcnt lgkmcnt(7)
    ds_read_b128 a[212:215], v252 offset:22528
    v_cvt_pk_bf16_f32 v27, v32, v33
    v_mfma_f32_16x16x32_bf16 v[8:11], a[128:131], a[216:219], v[8:11]
    buffer_load_dwordx4 v42, s[16:19], s8 offen offset:0 lds
    v_mfma_f32_16x16x32_bf16 v[8:11], a[136:139], a[220:223], v[8:11]
    s_add_u32 s47, s46, s61
    v_mfma_f32_16x16x32_bf16 v[12:15], a[132:135], a[216:219], v[12:15]
    ds_read_b128 a[216:219], v36 offset:24576
    v_mfma_f32_16x16x32_bf16 v[12:15], a[140:143], a[220:223], v[12:15]
    s_waitcnt lgkmcnt(7)
    ds_read_b128 a[220:223], v252 offset:24576
    v_subrev_u32 v36, 53248, v36
    v_mfma_f32_16x16x32_bf16 v[8:11], a[144:147], a[224:227], v[8:11]
    s_waitcnt vmcnt(16)
    buffer_store_dword v37, v45, s[24:27], s14 offen sc1
    v_mfma_f32_16x16x32_bf16 v[8:11], a[152:155], a[228:231], v[8:11]
    buffer_load_dwordx4 v253, s[16:19], s9 offen offset:1024 lds
    v_mfma_f32_16x16x32_bf16 v[12:15], a[148:151], a[224:227], v[12:15]
    buffer_store_dwordx4 v[24:27], v44, s[24:27], s1 offen sc1
    v_mfma_f32_16x16x32_bf16 v[12:15], a[156:159], a[228:231], v[12:15]
    s_waitcnt lgkmcnt(6)
    s_mov_b32 m0, s33
    v_subrev_u32 v252, 53248, v252
    v_mfma_f32_16x16x32_bf16 v[8:11], a[160:163], a[232:235], v[8:11]
    v_mfma_f32_16x16x32_bf16 v[8:11], a[168:171], a[236:239], v[8:11]
    buffer_load_dwordx4 v42, s[16:19], s10 offen offset:0 lds
    s_mov_b32 m0, s65
    s_waitcnt vmcnt(10) lgkmcnt(0)
    s_barrier
    v_mfma_f32_16x16x32_bf16 v[12:15], a[164:167], a[232:235], v[12:15]
    buffer_load_dwordx4 v40, s[20:23], s47 offen lds
    v_mfma_f32_16x16x32_bf16 v[12:15], a[172:175], a[236:239], v[12:15]
    s_add_u32 s46, s47, s61
    ds_read_b128 a[224:227], v36 offset:0
    v_accvgpr_write_b32 a244, v28
    v_mfma_f32_16x16x32_bf16 v[8:11], a[176:179], a[208:211], v[8:11]
    s_addk_i32 s14, 4096
    ds_read_b128 a[228:231], v252 offset:0
    v_accvgpr_write_b32 a245, v29
    v_mfma_f32_16x16x32_bf16 v[8:11], a[184:187], a[212:215], v[8:11]
    s_add_u32 s1, s1, s63
    ds_read_b128 a[232:235], v36 offset:2048
    v_accvgpr_write_b32 a246, v30
    v_mfma_f32_16x16x32_bf16 v[12:15], a[180:183], a[208:211], v[12:15]
    ds_read_b128 a[236:239], v252 offset:2048
    v_accvgpr_write_b32 a247, v31
    v_mfma_f32_16x16x32_bf16 v[12:15], a[188:191], a[212:215], v[12:15]
    ds_read_b128 a[208:211], v36 offset:4096
    v_lshlrev_b32 v32, 16, v28
    v_mfma_f32_16x16x32_bf16 v[8:11], a[192:195], a[216:219], v[8:11]
    ds_read_b128 a[212:215], v252 offset:4096
    v_and_b32 v33, s60, v28
    v_mfma_f32_16x16x32_bf16 v[8:11], a[200:203], a[220:223], v[8:11]
    buffer_load_dwordx4 v41, s[20:23], s47 offen offset:1024 lds
    v_mfma_f32_16x16x32_bf16 v[12:15], a[196:199], a[216:219], v[12:15]
    s_addk_i32 m0, 8192
    ds_read_b128 a[216:219], v36 offset:6144
    v_mbcnt_lo_u32_b32 v42, -1, 0
    v_mfma_f32_16x16x32_bf16 v[12:15], a[204:207], a[220:223], v[12:15]
    s_waitcnt lgkmcnt(5)
    ds_read_b128 a[220:223], v252 offset:6144
    v_mbcnt_hi_u32_b32 v42, -1, v42
    v_mfma_f32_16x16x32_bf16 v[0:3], a[0:3], a[224:227], v[16:19]
    buffer_load_dwordx4 v40, s[20:23], s46 offen lds
    v_mfma_f32_16x16x32_bf16 v[0:3], a[8:11], a[228:231], v[0:3]
    s_add_u32 s47, s46, s61
    ds_read_b64_tr_b16 v[184:185], v38 offset:32768
    ds_read_b64_tr_b16 v[186:187], v38 offset:36864
    v_mfma_f32_16x16x32_bf16 v[4:7], a[4:7], a[224:227], v[20:23]
    s_add_u32 s35, s35, s63
    ds_read_b128 a[224:227], v36 offset:8192
    v_lshlrev_b32 v42, 4, v42
    v_mfma_f32_16x16x32_bf16 v[4:7], a[12:15], a[228:231], v[4:7]
    s_waitcnt lgkmcnt(7)
    ds_read_b128 a[228:231], v252 offset:8192
    v_add_u32 v42, s44, v42
    v_mfma_f32_16x16x32_bf16 v[0:3], a[16:19], a[232:235], v[0:3]
    buffer_load_dwordx4 v41, s[20:23], s46 offen offset:1024 lds
    v_mfma_f32_16x16x32_bf16 v[0:3], a[24:27], a[236:239], v[0:3]
    s_addk_i32 m0, 8192
    ds_read_b64_tr_b16 v[188:189], v39 offset:32768
    ds_read_b64_tr_b16 v[190:191], v39 offset:36864
    v_mfma_f32_16x16x32_bf16 v[4:7], a[20:23], a[232:235], v[4:7]
    ds_read_b128 a[232:235], v36 offset:10240
    v_mul_f32 v32, v32, v8
    v_mfma_f32_16x16x32_bf16 v[4:7], a[28:31], a[236:239], v[4:7]
    s_waitcnt lgkmcnt(9)
    ds_read_b128 a[236:239], v252 offset:10240
    v_mul_f32 v33, v33, v9
    v_mfma_f32_16x16x32_bf16 v[0:3], a[32:35], a[208:211], v[0:3]
    buffer_load_dwordx4 v40, s[20:23], s47 offen lds
    v_mfma_f32_16x16x32_bf16 v[0:3], a[40:43], a[212:215], v[0:3]
    s_nop 0
    ds_read_b64_tr_b16 v[192:193], v38 offset:40960
    ds_read_b64_tr_b16 v[194:195], v38 offset:45056
    v_mfma_f32_16x16x32_bf16 v[4:7], a[36:39], a[208:211], v[4:7]
    ds_read_b128 a[208:211], v36 offset:12288
    v_cvt_pk_bf16_f32 v24, v32, v33
    v_mfma_f32_16x16x32_bf16 v[4:7], a[44:47], a[212:215], v[4:7]
    s_waitcnt lgkmcnt(11)
    ds_read_b128 a[212:215], v252 offset:12288
    v_lshlrev_b32 v32, 16, v29
    v_mfma_f32_16x16x32_bf16 v[0:3], a[48:51], a[216:219], v[0:3]
    buffer_load_dwordx4 v41, s[20:23], s47 offen offset:1024 lds
    v_mfma_f32_16x16x32_bf16 v[0:3], a[56:59], a[220:223], v[0:3]
    s_waitcnt vmcnt(13)
    v_cmp_ne_u32 vcc, s45, v47
    s_cbranch_vccnz L_slow8
L_back8:
    v_mfma_f32_16x16x32_bf16 v[4:7], a[52:55], a[216:219], v[4:7]
    s_mov_b32 m0, s69
    ds_read_b128 a[216:219], v36 offset:14336
    v_and_b32 v33, s60, v29
    v_mfma_f32_16x16x32_bf16 v[4:7], a[60:63], a[220:223], v[4:7]
    s_waitcnt lgkmcnt(9)
    ds_read_b128 a[220:223], v252 offset:14336
    v_mul_f32 v32, v32, v10
    v_mfma_f32_16x16x32_bf16 v[0:3], a[64:67], a[224:227], v[0:3]
    buffer_load_dwordx4 v42, s[24:27], s35 offen offset:0 sc1 lds
    v_mfma_f32_16x16x32_bf16 v[0:3], a[72:75], a[228:231], v[0:3]
    s_addk_i32 s49, 4096
    ds_read_b64_tr_b16 v[196:197], v39 offset:40960
    ds_read_b64_tr_b16 v[198:199], v39 offset:45056
    v_mfma_f32_16x16x32_bf16 v[4:7], a[68:71], a[224:227], v[4:7]
    s_add_u32 s54, s35, s64
    ds_read_b128 a[224:227], v36 offset:16384
    v_mul_f32 v33, v33, v11
    v_mfma_f32_16x16x32_bf16 v[4:7], a[76:79], a[228:231], v[4:7]
    s_waitcnt lgkmcnt(9)
    ds_read_b128 a[228:231], v252 offset:16384
    v_cvt_pk_bf16_f32 v25, v32, v33
    v_mfma_f32_16x16x32_bf16 v[0:3], a[80:83], a[232:235], v[0:3]
    buffer_load_dwordx4 v42, s[24:27], s35 offen offset:1024 sc1 lds
    v_mfma_f32_16x16x32_bf16 v[0:3], a[88:91], a[236:239], v[0:3]
    buffer_load_dword v47, v46, s[24:27], s49 offen sc1
    v_mfma_f32_16x16x32_bf16 v[4:7], a[84:87], a[232:235], v[4:7]
    ds_read_b128 a[232:235], v36 offset:18432
    v_lshlrev_b32 v32, 16, v30
    v_mfma_f32_16x16x32_bf16 v[4:7], a[92:95], a[236:239], v[4:7]
    s_waitcnt lgkmcnt(7)
    ds_read_b128 a[236:239], v252 offset:18432
    v_and_b32 v33, s60, v30
    v_mfma_f32_16x16x32_bf16 v[0:3], a[96:99], a[208:211], v[0:3]
    buffer_load_dwordx4 v42, s[24:27], s35 offen offset:2048 sc1 lds
    v_mfma_f32_16x16x32_bf16 v[0:3], a[104:107], a[212:215], v[0:3]
    s_nop 0
    ds_read_b64_tr_b16 v[200:201], v38 offset:49152
    ds_read_b64_tr_b16 v[202:203], v38 offset:53248
    v_mfma_f32_16x16x32_bf16 v[4:7], a[100:103], a[208:211], v[4:7]
    ds_read_b128 a[208:211], v36 offset:20480
    v_mul_f32 v32, v32, v12
    v_mfma_f32_16x16x32_bf16 v[4:7], a[108:111], a[212:215], v[4:7]
    s_waitcnt lgkmcnt(9)
    ds_read_b128 a[212:215], v252 offset:20480
    v_mul_f32 v33, v33, v13
    v_mfma_f32_16x16x32_bf16 v[0:3], a[112:115], a[216:219], v[0:3]
    buffer_load_dwordx4 v42, s[24:27], s35 offen offset:3072 sc1 lds
    v_mfma_f32_16x16x32_bf16 v[0:3], a[120:123], a[220:223], v[0:3]
    s_addk_i32 m0, 4096
    ds_read_b64_tr_b16 v[204:205], v39 offset:49152
    ds_read_b64_tr_b16 v[206:207], v39 offset:53248
    v_mfma_f32_16x16x32_bf16 v[4:7], a[116:119], a[216:219], v[4:7]
    s_add_u32 s0, s0, s63
    ds_read_b128 a[216:219], v36 offset:22528
    v_cvt_pk_bf16_f32 v26, v32, v33
    v_mfma_f32_16x16x32_bf16 v[4:7], a[124:127], a[220:223], v[4:7]
    s_waitcnt lgkmcnt(9)
    ds_read_b128 a[220:223], v252 offset:22528
    v_lshlrev_b32 v32, 16, v31
    v_mfma_f32_16x16x32_bf16 v[0:3], a[128:131], a[224:227], v[0:3]
    buffer_load_dwordx4 v42, s[24:27], s54 offen offset:0 sc1 lds
    v_mfma_f32_16x16x32_bf16 v[0:3], a[136:139], a[228:231], v[0:3]
    v_and_b32 v33, s60, v31
    ds_read_b64 v[28:29], v254 offset:0
    s_add_u32 s46, s47, s61
    v_mfma_f32_16x16x32_bf16 v[4:7], a[132:135], a[224:227], v[4:7]
    s_nop 0
    ds_read_b128 a[224:227], v36 offset:24576
    ds_read_b64 v[30:31], v255 offset:0
    v_mfma_f32_16x16x32_bf16 v[4:7], a[140:143], a[228:231], v[4:7]
    s_waitcnt lgkmcnt(11)
    ds_read_b128 a[228:231], v252 offset:24576
    v_add_u32 v36, 26624, v36
    v_mfma_f32_16x16x32_bf16 v[0:3], a[144:147], a[232:235], v[0:3]
    s_waitcnt vmcnt(13)
    buffer_store_dword v37, v45, s[24:27], s14 offen sc1
    v_mfma_f32_16x16x32_bf16 v[0:3], a[152:155], a[236:239], v[0:3]
    buffer_load_dwordx4 v42, s[24:27], s54 offen offset:1024 sc1 lds
    v_mfma_f32_16x16x32_bf16 v[4:7], a[148:151], a[232:235], v[4:7]
    s_mov_b32 m0, s34
    v_add_u32 v252, 26624, v252
    v_mul_f32 v32, v32, v14
    v_mfma_f32_16x16x32_bf16 v[4:7], a[156:159], a[236:239], v[4:7]
    s_waitcnt lgkmcnt(8)
    v_mul_f32 v33, v33, v15
    v_cvt_pk_bf16_f32 v27, v32, v33
    v_mfma_f32_16x16x32_bf16 v[0:3], a[160:163], a[208:211], v[0:3]
    buffer_store_dwordx4 v[24:27], v44, s[24:27], s1 offen sc1
    v_mfma_f32_16x16x32_bf16 v[0:3], a[168:171], a[212:215], v[0:3]
    buffer_load_dwordx4 v42, s[24:27], s0 offen offset:0 sc1 lds
    s_mov_b32 m0, s66
    s_waitcnt vmcnt(10) lgkmcnt(0)
    s_barrier
    v_mfma_f32_16x16x32_bf16 v[4:7], a[164:167], a[208:211], v[4:7]
    buffer_load_dwordx4 v40, s[20:23], s46 offen lds
    v_mfma_f32_16x16x32_bf16 v[4:7], a[172:175], a[212:215], v[4:7]
    s_add_u32 s47, s46, s61
    ds_read_b128 a[232:235], v36 offset:0
    v_accvgpr_write_b32 a248, v28
    v_mfma_f32_16x16x32_bf16 v[0:3], a[176:179], a[216:219], v[0:3]
    s_addk_i32 s14, 4096
    ds_read_b128 a[236:239], v252 offset:0
    v_accvgpr_write_b32 a249, v29
    v_mfma_f32_16x16x32_bf16 v[0:3], a[184:187], a[220:223], v[0:3]
    s_add_u32 s1, s1, s63
    ds_read_b128 a[208:211], v36 offset:2048
    v_accvgpr_write_b32 a250, v30
    v_mfma_f32_16x16x32_bf16 v[4:7], a[180:183], a[216:219], v[4:7]
    ds_read_b128 a[212:215], v252 offset:2048
    v_accvgpr_write_b32 a251, v31
    v_mfma_f32_16x16x32_bf16 v[4:7], a[188:191], a[220:223], v[4:7]
    ds_read_b128 a[216:219], v36 offset:4096
    v_lshlrev_b32 v32, 16, v28
    v_mfma_f32_16x16x32_bf16 v[0:3], a[192:195], a[224:227], v[0:3]
    ds_read_b128 a[220:223], v252 offset:4096
    v_and_b32 v33, s60, v28
    v_mfma_f32_16x16x32_bf16 v[0:3], a[200:203], a[228:231], v[0:3]
    buffer_load_dwordx4 v41, s[20:23], s46 offen offset:1024 lds
    v_mfma_f32_16x16x32_bf16 v[4:7], a[196:199], a[224:227], v[4:7]
    s_addk_i32 m0, 8192
    ds_read_b128 a[224:227], v36 offset:6144
    ds_read_b64_tr_b16 v[208:209], v38 offset:0
    v_mfma_f32_16x16x32_bf16 v[4:7], a[204:207], a[228:231], v[4:7]
    s_waitcnt lgkmcnt(6)
    ds_read_b128 a[228:231], v252 offset:6144
    ds_read_b64_tr_b16 v[210:211], v38 offset:4096
    v_mfma_f32_16x16x32_bf16 v[8:11], a[0:3], a[232:235], v[16:19]
    buffer_load_dwordx4 v40, s[20:23], s47 offen lds
    v_mfma_f32_16x16x32_bf16 v[8:11], a[8:11], a[236:239], v[8:11]
    s_add_u32 s46, s47, s61
    ds_read_b64_tr_b16 v[212:213], v39 offset:0
    ds_read_b64_tr_b16 v[214:215], v39 offset:4096
    v_mfma_f32_16x16x32_bf16 v[12:15], a[4:7], a[232:235], v[20:23]
    s_add_u32 s35, s35, s63
    ds_read_b128 a[232:235], v36 offset:8192
    v_mul_f32 v32, v32, v0
    v_mfma_f32_16x16x32_bf16 v[12:15], a[12:15], a[236:239], v[12:15]
    s_waitcnt lgkmcnt(9)
    ds_read_b128 a[236:239], v252 offset:8192
    v_mul_f32 v33, v33, v1
    v_mfma_f32_16x16x32_bf16 v[8:11], a[16:19], a[208:211], v[8:11]
    buffer_load_dwordx4 v41, s[20:23], s47 offen offset:1024 lds
    v_mfma_f32_16x16x32_bf16 v[8:11], a[24:27], a[212:215], v[8:11]
    s_addk_i32 m0, 8192
    ds_read_b64_tr_b16 v[216:217], v38 offset:8192
    ds_read_b64_tr_b16 v[218:219], v38 offset:12288
    v_mfma_f32_16x16x32_bf16 v[12:15], a[20:23], a[208:211], v[12:15]
    ds_read_b128 a[208:211], v36 offset:10240
    v_cvt_pk_bf16_f32 v24, v32, v33
    v_mfma_f32_16x16x32_bf16 v[12:15], a[28:31], a[212:215], v[12:15]
    s_waitcnt lgkmcnt(11)
    ds_read_b128 a[212:215], v252 offset:10240
    v_lshlrev_b32 v32, 16, v29
    v_mfma_f32_16x16x32_bf16 v[8:11], a[32:35], a[216:219], v[8:11]
    buffer_load_dwordx4 v40, s[20:23], s46 offen lds
    v_mfma_f32_16x16x32_bf16 v[8:11], a[40:43], a[220:223], v[8:11]
    s_nop 0
    ds_read_b64_tr_b16 v[220:221], v39 offset:8192
    ds_read_b64_tr_b16 v[222:223], v39 offset:12288
L_page3:
    s_cbranch_execz L_page7
    v_mfma_f32_16x16x32_bf16 v[12:15], a[36:39], a[216:219], v[12:15]
    ds_read_b128 a[216:219], v36 offset:12288
    v_and_b32 v33, s60, v29
    v_mfma_f32_16x16x32_bf16 v[12:15], a[44:47], a[220:223], v[12:15]
    s_waitcnt lgkmcnt(12)
    ds_read_b128 a[220:223], v252 offset:12288
    v_mul_f32 v32, v32, v2
    v_mfma_f32_16x16x32_bf16 v[8:11], a[48:51], a[224:227], v[8:11]
    buffer_load_dwordx4 v41, s[20:23], s46 offen offset:1024 lds
    v_mfma_f32_16x16x32_bf16 v[8:11], a[56:59], a[228:231], v[8:11]
    s_waitcnt vmcnt(13)
    v_cmp_ne_u32 vcc, s45, v47
    s_cbranch_vccnz L_slow9
L_back9:
    v_mfma_f32_16x16x32_bf16 v[12:15], a[52:55], a[224:227], v[12:15]
    s_mov_b32 m0, s67
    ds_read_b128 a[224:227], v36 offset:14336
    v_mul_f32 v33, v33, v3
    v_mfma_f32_16x16x32_bf16 v[12:15], a[60:63], a[228:231], v[12:15]
    s_waitcnt lgkmcnt(9)
    ds_read_b128 a[228:231], v252 offset:14336
    v_cvt_pk_bf16_f32 v25, v32, v33
    v_mfma_f32_16x16x32_bf16 v[8:11], a[64:67], a[232:235], v[8:11]
    buffer_load_dwordx4 v42, s[24:27], s35 offen offset:0 sc1 lds
    v_mfma_f32_16x16x32_bf16 v[8:11], a[72:75], a[236:239], v[8:11]
    s_addk_i32 s49, 4096
    ds_read_b64_tr_b16 v[224:225], v38 offset:16384
    ds_read_b64_tr_b16 v[226:227], v38 offset:20480
    v_mfma_f32_16x16x32_bf16 v[12:15], a[68:71], a[232:235], v[12:15]
    s_add_u32 s54, s35, s64
    ds_read_b128 a[232:235], v36 offset:16384
    v_lshlrev_b32 v32, 16, v30
    v_mfma_f32_16x16x32_bf16 v[12:15], a[76:79], a[236:239], v[12:15]
    s_waitcnt lgkmcnt(9)
    ds_read_b128 a[236:239], v252 offset:16384
    v_and_b32 v33, s60, v30
    v_mfma_f32_16x16x32_bf16 v[8:11], a[80:83], a[208:211], v[8:11]
    buffer_load_dwordx4 v42, s[24:27], s35 offen offset:1024 sc1 lds
    v_mfma_f32_16x16x32_bf16 v[8:11], a[88:91], a[212:215], v[8:11]
    buffer_load_dword v47, v46, s[24:27], s49 offen sc1
    v_mfma_f32_16x16x32_bf16 v[12:15], a[84:87], a[208:211], v[12:15]
    ds_read_b128 a[208:211], v36 offset:18432
    v_mul_f32 v32, v32, v4
    v_mfma_f32_16x16x32_bf16 v[12:15], a[92:95], a[212:215], v[12:15]
    s_waitcnt lgkmcnt(7)
    ds_read_b128 a[212:215], v252 offset:18432
    v_mul_f32 v33, v33, v5
    v_mfma_f32_16x16x32_bf16 v[8:11], a[96:99], a[216:219], v[8:11]
    buffer_load_dwordx4 v42, s[24:27], s35 offen offset:2048 sc1 lds
    v_mfma_f32_16x16x32_bf16 v[8:11], a[104:107], a[220:223], v[8:11]
    s_nop 0
    ds_read_b64_tr_b16 v[228:229], v39 offset:16384
    ds_read_b64_tr_b16 v[230:231], v39 offset:20480
    v_mfma_f32_16x16x32_bf16 v[12:15], a[100:103], a[216:219], v[12:15]
    ds_read_b128 a[216:219], v36 offset:20480
    v_cvt_pk_bf16_f32 v26, v32, v33
    v_mfma_f32_16x16x32_bf16 v[12:15], a[108:111], a[220:223], v[12:15]
    s_waitcnt lgkmcnt(9)
    ds_read_b128 a[220:223], v252 offset:20480
    v_lshlrev_b32 v32, 16, v31
    v_mfma_f32_16x16x32_bf16 v[8:11], a[112:115], a[224:227], v[8:11]
    buffer_load_dwordx4 v42, s[24:27], s35 offen offset:3072 sc1 lds
    v_mfma_f32_16x16x32_bf16 v[8:11], a[120:123], a[228:231], v[8:11]
    v_and_b32 v33, s60, v31
    ds_read_b64 v[28:29], v254 offset:26624
    s_addk_i32 m0, 4096
    v_mfma_f32_16x16x32_bf16 v[12:15], a[116:119], a[224:227], v[12:15]
    s_add_u32 s0, s0, s63
    ds_read_b128 a[224:227], v36 offset:22528
    ds_read_b64 v[30:31], v255 offset:26624
    v_mfma_f32_16x16x32_bf16 v[12:15], a[124:127], a[228:231], v[12:15]
    s_waitcnt lgkmcnt(9)
    ds_read_b128 a[228:231], v252 offset:22528
    v_mul_f32 v32, v32, v6
    v_mfma_f32_16x16x32_bf16 v[8:11], a[128:131], a[232:235], v[8:11]
    buffer_load_dwordx4 v42, s[24:27], s54 offen offset:0 sc1 lds
    v_mfma_f32_16x16x32_bf16 v[8:11], a[136:139], a[236:239], v[8:11]
    s_add_u32 s20, s20, 1384448
    s_addc_u32 s21, s21, 0
    v_mul_f32 v33, v33, v7
    v_mfma_f32_16x16x32_bf16 v[12:15], a[132:135], a[232:235], v[12:15]
    s_mov_b32 s22, 1384448
    ds_read_b128 a[232:235], v36 offset:24576
    v_cvt_pk_bf16_f32 v27, v32, v33
    v_mfma_f32_16x16x32_bf16 v[12:15], a[140:143], a[236:239], v[12:15]
    s_waitcnt lgkmcnt(9)
    ds_read_b128 a[236:239], v252 offset:24576
    v_mbcnt_lo_u32_b32 v36, -1, 0
    v_mfma_f32_16x16x32_bf16 v[8:11], a[144:147], a[208:211], v[8:11]
    s_waitcnt vmcnt(13)
    buffer_store_dword v37, v45, s[24:27], s14 offen sc1
    v_mfma_f32_16x16x32_bf16 v[8:11], a[152:155], a[212:215], v[8:11]
    buffer_load_dwordx4 v42, s[24:27], s54 offen offset:1024 sc1 lds
    v_mfma_f32_16x16x32_bf16 v[12:15], a[148:151], a[208:211], v[12:15]
    buffer_store_dwordx4 v[24:27], v44, s[24:27], s1 offen sc1
    v_mfma_f32_16x16x32_bf16 v[12:15], a[156:159], a[212:215], v[12:15]
    s_waitcnt lgkmcnt(6)
    v_mbcnt_hi_u32_b32 v36, -1, v36
    v_lshlrev_b32 v36, 4, v36
    v_mfma_f32_16x16x32_bf16 v[8:11], a[160:163], a[216:219], v[8:11]
    s_mov_b32 s47, 0
    v_add_u32 v36, 53248, v36
    v_mbcnt_lo_u32_b32 v35, -1, 0
    v_mfma_f32_16x16x32_bf16 v[8:11], a[168:171], a[220:223], v[8:11]
    s_mov_b32 m0, s32
    v_mbcnt_hi_u32_b32 v35, -1, v35
    buffer_load_dwordx4 v42, s[24:27], s0 offen offset:0 sc1 lds
    s_mov_b32 m0, s65
    s_lshl_b32 s56, s3, 8
    v_and_b32 v35, 48, v35
    s_add_u32 s56, s56, 161792
    v_add_u32 v35, s56, v35
    ds_read_b128 v[16:19], v35 offset:0
    ds_read_b128 v[20:23], v35 offset:64
    s_waitcnt vmcnt(10) lgkmcnt(0)
    s_barrier
    v_mfma_f32_16x16x32_bf16 v[12:15], a[164:167], a[216:219], v[12:15]
    buffer_load_dwordx4 v40, s[20:23], s47 offen lds
    v_mfma_f32_16x16x32_bf16 v[12:15], a[172:175], a[220:223], v[12:15]
    s_add_u32 s46, s47, s61
    ds_read_b128 a[208:211], v36 offset:0
    v_accvgpr_write_b32 a252, v28
    v_mfma_f32_16x16x32_bf16 v[8:11], a[176:179], a[224:227], v[8:11]
    s_addk_i32 s14, 4096
    ds_read_b128 a[212:215], v36 offset:1024
    v_accvgpr_write_b32 a253, v29
    v_mfma_f32_16x16x32_bf16 v[8:11], a[184:187], a[228:231], v[8:11]
    s_add_u32 s1, s1, s63
    ds_read_b128 a[216:219], v36 offset:2048
    v_accvgpr_write_b32 a254, v30
    v_mfma_f32_16x16x32_bf16 v[12:15], a[180:183], a[224:227], v[12:15]
    ds_read_b128 a[220:223], v36 offset:3072
    v_accvgpr_write_b32 a255, v31
    v_mfma_f32_16x16x32_bf16 v[12:15], a[188:191], a[228:231], v[12:15]
    ds_read_b128 a[224:227], v36 offset:4096
    v_lshlrev_b32 v32, 16, v28
    v_mfma_f32_16x16x32_bf16 v[8:11], a[192:195], a[232:235], v[8:11]
    ds_read_b128 a[228:231], v36 offset:5120
    v_and_b32 v33, s60, v28
    v_mfma_f32_16x16x32_bf16 v[8:11], a[200:203], a[236:239], v[8:11]
    buffer_load_dwordx4 v41, s[20:23], s47 offen offset:1024 lds
    v_mfma_f32_16x16x32_bf16 v[12:15], a[196:199], a[232:235], v[12:15]
    s_add_u32 s47, s46, s61
    ds_read_b128 a[232:235], v36 offset:6144
    ds_read_b64_tr_b16 v[232:233], v38 offset:32768
    v_mfma_f32_16x16x32_bf16 v[12:15], a[204:207], a[236:239], v[12:15]
    s_waitcnt lgkmcnt(6)
    ds_read_b128 a[236:239], v36 offset:7168
    ds_read_b64_tr_b16 v[234:235], v38 offset:36864
    v_mfma_f32_16x16x32_bf16 v[0:3], v[48:51], a[208:211], v[16:19]
    s_addk_i32 m0, 8192
    ds_read_b64_tr_b16 v[236:237], v39 offset:32768
    ds_read_b64_tr_b16 v[238:239], v39 offset:36864
    v_mfma_f32_16x16x32_bf16 v[0:3], v[56:59], a[212:215], v[0:3]
    buffer_load_dwordx4 v40, s[20:23], s46 offen lds
    v_mfma_f32_16x16x32_bf16 v[4:7], v[52:55], a[208:211], v[20:23]
    ds_read_b128 a[208:211], v36 offset:8192
    v_mul_f32 v32, v32, v8
    v_mfma_f32_16x16x32_bf16 v[4:7], v[60:63], a[212:215], v[4:7]
    s_waitcnt lgkmcnt(9)
    ds_read_b128 a[212:215], v36 offset:9216
    v_mul_f32 v33, v33, v9
    v_mfma_f32_16x16x32_bf16 v[0:3], v[64:67], a[216:219], v[0:3]
    buffer_load_dwordx4 v41, s[20:23], s46 offen offset:1024 lds
    v_mfma_f32_16x16x32_bf16 v[0:3], v[72:75], a[220:223], v[0:3]
    s_addk_i32 m0, 8192
    ds_read_b64_tr_b16 v[240:241], v38 offset:40960
    ds_read_b64_tr_b16 v[242:243], v38 offset:45056
    v_mfma_f32_16x16x32_bf16 v[4:7], v[68:71], a[216:219], v[4:7]
    s_add_u32 s46, s47, s61
    ds_read_b128 a[216:219], v36 offset:10240
    v_cvt_pk_bf16_f32 v24, v32, v33
    v_mfma_f32_16x16x32_bf16 v[4:7], v[76:79], a[220:223], v[4:7]
    s_waitcnt lgkmcnt(11)
    ds_read_b128 a[220:223], v36 offset:11264
    v_lshlrev_b32 v32, 16, v29
    v_mfma_f32_16x16x32_bf16 v[0:3], v[80:83], a[224:227], v[0:3]
    buffer_load_dwordx4 v40, s[20:23], s47 offen lds
    v_mfma_f32_16x16x32_bf16 v[0:3], v[88:91], a[228:231], v[0:3]
    buffer_load_dwordx4 v41, s[20:23], s47 offen offset:1024 lds
    v_mfma_f32_16x16x32_bf16 v[4:7], v[84:87], a[224:227], v[4:7]
    s_addk_i32 m0, 8192
    ds_read_b128 a[224:227], v36 offset:12288
    v_and_b32 v33, s60, v29
    v_mfma_f32_16x16x32_bf16 v[4:7], v[92:95], a[228:231], v[4:7]
    s_waitcnt lgkmcnt(10)
    ds_read_b128 a[228:231], v36 offset:13312
    v_mul_f32 v32, v32, v10
    v_mfma_f32_16x16x32_bf16 v[0:3], v[96:99], a[232:235], v[0:3]
    buffer_load_dwordx4 v40, s[20:23], s46 offen lds
    v_mfma_f32_16x16x32_bf16 v[0:3], v[104:107], a[236:239], v[0:3]
    s_add_u32 s35, s35, s63
    ds_read_b64_tr_b16 v[244:245], v39 offset:40960
    ds_read_b64_tr_b16 v[246:247], v39 offset:45056
    v_mfma_f32_16x16x32_bf16 v[4:7], v[100:103], a[232:235], v[4:7]
    ds_read_b128 a[232:235], v36 offset:14336
    v_mul_f32 v33, v33, v11
    v_mfma_f32_16x16x32_bf16 v[4:7], v[108:111], a[236:239], v[4:7]
    s_waitcnt lgkmcnt(9)
    ds_read_b128 a[236:239], v36 offset:15360
    v_cvt_pk_bf16_f32 v25, v32, v33
    v_mfma_f32_16x16x32_bf16 v[0:3], v[112:115], a[208:211], v[0:3]
    buffer_load_dwordx4 v41, s[20:23], s46 offen offset:1024 lds
    v_mfma_f32_16x16x32_bf16 v[0:3], v[120:123], a[212:215], v[0:3]
    s_waitcnt vmcnt(15)
    v_cmp_ne_u32 vcc, s45, v47
    s_cbranch_vccnz L_slow10
L_back10:
    v_mfma_f32_16x16x32_bf16 v[4:7], v[116:119], a[208:211], v[4:7]
    s_mov_b32 m0, s68
    ds_read_b128 a[208:211], v36 offset:16384
    v_lshlrev_b32 v32, 16, v30
    v_mfma_f32_16x16x32_bf16 v[4:7], v[124:127], a[212:215], v[4:7]
    s_waitcnt lgkmcnt(7)
    ds_read_b128 a[212:215], v36 offset:17408
    v_and_b32 v33, s60, v30
    v_mfma_f32_16x16x32_bf16 v[0:3], v[128:131], a[216:219], v[0:3]
    buffer_load_dwordx4 v42, s[24:27], s35 offen offset:0 sc1 lds
    v_mfma_f32_16x16x32_bf16 v[0:3], v[136:139], a[220:223], v[0:3]
    s_addk_i32 s49, 4096
    ds_read_b64_tr_b16 v[248:249], v38 offset:49152
    ds_read_b64_tr_b16 v[250:251], v38 offset:53248
    v_mfma_f32_16x16x32_bf16 v[4:7], v[132:135], a[216:219], v[4:7]
    s_add_u32 s54, s35, s64
    ds_read_b128 a[216:219], v36 offset:18432
    v_mul_f32 v32, v32, v12
    v_mfma_f32_16x16x32_bf16 v[4:7], v[140:143], a[220:223], v[4:7]
    s_waitcnt lgkmcnt(9)
    ds_read_b128 a[220:223], v36 offset:19456
    v_mul_f32 v33, v33, v13
    v_mfma_f32_16x16x32_bf16 v[0:3], v[144:147], a[224:227], v[0:3]
    buffer_load_dword v47, v46, s[24:27], s49 offen sc1
    v_mfma_f32_16x16x32_bf16 v[0:3], v[152:155], a[228:231], v[0:3]
    buffer_load_dwordx4 v42, s[24:27], s35 offen offset:1024 sc1 lds
    v_mfma_f32_16x16x32_bf16 v[4:7], v[148:151], a[224:227], v[4:7]
    ds_read_b128 a[224:227], v36 offset:20480
    v_cvt_pk_bf16_f32 v26, v32, v33
    v_mfma_f32_16x16x32_bf16 v[4:7], v[156:159], a[228:231], v[4:7]
    s_waitcnt lgkmcnt(7)
    ds_read_b128 a[228:231], v36 offset:21504
    v_lshlrev_b32 v32, 16, v31
    v_mfma_f32_16x16x32_bf16 v[0:3], v[160:163], a[232:235], v[0:3]
    buffer_load_dwordx4 v42, s[24:27], s35 offen offset:2048 sc1 lds
    v_mfma_f32_16x16x32_bf16 v[0:3], v[168:171], a[236:239], v[0:3]
    buffer_load_dwordx4 v42, s[24:27], s35 offen offset:3072 sc1 lds
    v_mfma_f32_16x16x32_bf16 v[4:7], v[164:167], a[232:235], v[4:7]
    s_addk_i32 m0, 4096
    ds_read_b128 a[232:235], v36 offset:22528
    v_and_b32 v33, s60, v31
    v_mfma_f32_16x16x32_bf16 v[4:7], v[172:175], a[236:239], v[4:7]
    s_waitcnt lgkmcnt(7)
    ds_read_b128 a[236:239], v36 offset:23552
    v_mul_f32 v32, v32, v14
    v_mfma_f32_16x16x32_bf16 v[0:3], v[176:179], a[208:211], v[0:3]
    s_add_u32 s0, s0, s63
    ds_read_b64_tr_b16 v[252:253], v39 offset:49152
    ds_read_b64_tr_b16 v[254:255], v39 offset:53248
    v_mfma_f32_16x16x32_bf16 v[0:3], v[184:187], a[212:215], v[0:3]
    buffer_load_dwordx4 v42, s[24:27], s54 offen offset:0 sc1 lds
    v_mfma_f32_16x16x32_bf16 v[4:7], v[180:183], a[208:211], v[4:7]
    s_add_u32 s47, s46, s61
    ds_read_b128 a[208:211], v36 offset:24576
    v_mul_f32 v33, v33, v15
    v_mfma_f32_16x16x32_bf16 v[4:7], v[188:191], a[212:215], v[4:7]
    s_waitcnt lgkmcnt(7)
    ds_read_b128 a[212:215], v36 offset:25600
    v_subrev_u32 v36, 53248, v36
    v_mfma_f32_16x16x32_bf16 v[0:3], v[192:195], a[216:219], v[0:3]
    s_waitcnt vmcnt(15)
    buffer_store_dword v37, v45, s[24:27], s14 offen sc1
    v_mfma_f32_16x16x32_bf16 v[0:3], v[200:203], a[220:223], v[0:3]
    buffer_load_dwordx4 v42, s[24:27], s54 offen offset:1024 sc1 lds
    v_mfma_f32_16x16x32_bf16 v[4:7], v[196:199], a[216:219], v[4:7]
    s_mov_b32 m0, s33
    v_cvt_pk_bf16_f32 v27, v32, v33
    v_mfma_f32_16x16x32_bf16 v[4:7], v[204:207], a[220:223], v[4:7]
    s_waitcnt lgkmcnt(6)
    buffer_store_dwordx4 v[24:27], v44, s[24:27], s1 offen sc1
    v_mfma_f32_16x16x32_bf16 v[0:3], v[208:211], a[224:227], v[0:3]
    ds_read_b128 v[24:27], v44 offset:53248
    v_mfma_f32_16x16x32_bf16 v[0:3], v[216:219], a[228:231], v[0:3]
    buffer_load_dwordx4 v42, s[24:27], s0 offen offset:0 sc1 lds
    s_mov_b32 m0, s66
    s_waitcnt vmcnt(10) lgkmcnt(0)
    s_barrier
    v_mfma_f32_16x16x32_bf16 v[4:7], v[212:215], a[224:227], v[4:7]
    buffer_load_dwordx4 v40, s[20:23], s47 offen lds
    v_mfma_f32_16x16x32_bf16 v[4:7], v[220:223], a[228:231], v[4:7]
    s_add_u32 s46, s47, s61
    ds_read_b128 a[216:219], v36 offset:0
    ds_read_b128 v[28:31], v43 offset:0
    v_mfma_f32_16x16x32_bf16 v[0:3], v[224:227], a[232:235], v[0:3]
    s_addk_i32 s14, 4096
    ds_read_b128 a[220:223], v36 offset:1024
    v_lshlrev_b32 v33, 16, v24
    v_mfma_f32_16x16x32_bf16 v[0:3], v[232:235], a[236:239], v[0:3]
    s_add_u32 s1, s1, s63
    ds_read_b128 a[224:227], v36 offset:2048
    v_and_b32 v35, s60, v24
    v_mfma_f32_16x16x32_bf16 v[4:7], v[228:231], a[232:235], v[4:7]
    s_nop 0
    ds_read_b128 a[228:231], v36 offset:3072
    ds_read_b64_tr_b16 a[0:1], v38 offset:0
    v_mfma_f32_16x16x32_bf16 v[4:7], v[236:239], a[236:239], v[4:7]
    s_nop 0
    ds_read_b128 a[232:235], v36 offset:4096
    ds_read_b64_tr_b16 a[2:3], v38 offset:4096
    v_mfma_f32_16x16x32_bf16 v[0:3], v[240:243], a[208:211], v[0:3]
    s_nop 0
    ds_read_b128 a[236:239], v36 offset:5120
    ds_read_b64_tr_b16 a[4:5], v39 offset:0
    v_mfma_f32_16x16x32_bf16 v[0:3], v[248:251], a[212:215], v[0:3]
    buffer_load_dwordx4 v41, s[20:23], s47 offen offset:1024 lds
    v_mfma_f32_16x16x32_bf16 v[4:7], v[244:247], a[208:211], v[4:7]
    s_waitcnt lgkmcnt(8)
    ds_read_b128 a[208:211], v36 offset:6144
    v_lshlrev_b32 v32, 16, v28
    v_mfma_f32_16x16x32_bf16 v[4:7], v[252:255], a[212:215], v[4:7]
    s_waitcnt lgkmcnt(8)
    ds_read_b128 a[212:215], v36 offset:7168
    v_and_b32 v34, s60, v28
    v_mfma_f32_16x16x32_bf16 v[8:11], v[48:51], a[216:219], v[16:19]
    s_add_u32 s47, s46, s61
    ds_read_b64_tr_b16 a[6:7], v39 offset:4096
    ds_read_b64_tr_b16 a[8:9], v38 offset:8192
    v_mfma_f32_16x16x32_bf16 v[8:11], v[56:59], a[220:223], v[8:11]
    s_addk_i32 m0, 8192
    ds_read_b64_tr_b16 a[10:11], v38 offset:12288
    ds_read_b64_tr_b16 a[12:13], v39 offset:8192
    v_mfma_f32_16x16x32_bf16 v[12:15], v[52:55], a[216:219], v[20:23]
    ds_read_b128 a[216:219], v36 offset:8192
    v_fmac_f32 v33, v32, v0
    v_mfma_f32_16x16x32_bf16 v[12:15], v[60:63], a[220:223], v[12:15]
    s_waitcnt lgkmcnt(12)
    ds_read_b128 a[220:223], v36 offset:9216
    v_fmac_f32 v35, v34, v1
    v_mfma_f32_16x16x32_bf16 v[8:11], v[64:67], a[224:227], v[8:11]
    buffer_load_dwordx4 v40, s[20:23], s46 offen lds
    v_mfma_f32_16x16x32_bf16 v[8:11], v[72:75], a[228:231], v[8:11]
    buffer_load_dwordx4 v41, s[20:23], s46 offen offset:1024 lds
    v_mfma_f32_16x16x32_bf16 v[12:15], v[68:71], a[224:227], v[12:15]
    s_addk_i32 m0, 8192
    ds_read_b128 a[224:227], v36 offset:10240
    v_cvt_pk_bf16_f32 v28, v33, v35
    v_mfma_f32_16x16x32_bf16 v[12:15], v[76:79], a[228:231], v[12:15]
    s_waitcnt lgkmcnt(10)
    ds_read_b128 a[228:231], v36 offset:11264
    v_lshlrev_b32 v33, 16, v25
    v_mfma_f32_16x16x32_bf16 v[8:11], v[80:83], a[232:235], v[8:11]
    buffer_load_dwordx4 v40, s[20:23], s47 offen lds
    v_mfma_f32_16x16x32_bf16 v[8:11], v[88:91], a[236:239], v[8:11]
    buffer_load_dwordx4 v41, s[20:23], s47 offen offset:1024 lds
    v_mfma_f32_16x16x32_bf16 v[12:15], v[84:87], a[232:235], v[12:15]
    s_add_u32 s46, s47, s61
    ds_read_b128 a[232:235], v36 offset:12288
    v_and_b32 v35, s60, v25
    v_mfma_f32_16x16x32_bf16 v[12:15], v[92:95], a[236:239], v[12:15]
    s_waitcnt lgkmcnt(9)
    ds_read_b128 a[236:239], v36 offset:13312
    v_lshlrev_b32 v32, 16, v29
    v_mfma_f32_16x16x32_bf16 v[8:11], v[96:99], a[208:211], v[8:11]
    s_addk_i32 m0, 8192
    ds_read_b64_tr_b16 a[14:15], v39 offset:12288
    ds_read_b64_tr_b16 a[16:17], v38 offset:16384
    v_mfma_f32_16x16x32_bf16 v[8:11], v[104:107], a[212:215], v[8:11]
    buffer_load_dwordx4 v40, s[20:23], s46 offen lds
    v_mfma_f32_16x16x32_bf16 v[12:15], v[100:103], a[208:211], v[12:15]
    s_add_u32 s35, s35, s63
    ds_read_b128 a[208:211], v36 offset:14336
    v_and_b32 v34, s60, v29
    v_mfma_f32_16x16x32_bf16 v[12:15], v[108:111], a[212:215], v[12:15]
    s_waitcnt lgkmcnt(7)
    ds_read_b128 a[212:215], v36 offset:15360
    v_fmac_f32 v33, v32, v2
    v_mfma_f32_16x16x32_bf16 v[8:11], v[112:115], a[216:219], v[8:11]
    buffer_load_dwordx4 v41, s[20:23], s46 offen offset:1024 lds
    v_mfma_f32_16x16x32_bf16 v[8:11], v[120:123], a[220:223], v[8:11]
    s_waitcnt vmcnt(16)
    v_cmp_ne_u32 vcc, s45, v47
    s_cbranch_vccnz L_slow11
L_back11:
    v_mfma_f32_16x16x32_bf16 v[12:15], v[116:119], a[216:219], v[12:15]
    s_mov_b32 m0, s69
    ds_read_b128 a[216:219], v36 offset:16384
    v_fmac_f32 v35, v34, v3
    v_mfma_f32_16x16x32_bf16 v[12:15], v[124:127], a[220:223], v[12:15]
    s_waitcnt lgkmcnt(7)
    ds_read_b128 a[220:223], v36 offset:17408
    v_cvt_pk_bf16_f32 v29, v33, v35
    v_mfma_f32_16x16x32_bf16 v[8:11], v[128:131], a[224:227], v[8:11]
    buffer_load_dwordx4 v42, s[24:27], s35 offen offset:0 sc1 lds
    v_mfma_f32_16x16x32_bf16 v[8:11], v[136:139], a[228:231], v[8:11]
    s_addk_i32 s49, 4096
    ds_read_b64_tr_b16 a[18:19], v38 offset:20480
    ds_read_b64_tr_b16 a[20:21], v39 offset:16384
    v_mfma_f32_16x16x32_bf16 v[12:15], v[132:135], a[224:227], v[12:15]
    s_add_u32 s54, s35, s64
    ds_read_b128 a[224:227], v36 offset:18432
    v_lshlrev_b32 v33, 16, v26
    v_mfma_f32_16x16x32_bf16 v[12:15], v[140:143], a[228:231], v[12:15]
    s_waitcnt lgkmcnt(9)
    ds_read_b128 a[228:231], v36 offset:19456
    v_and_b32 v35, s60, v26
    v_mfma_f32_16x16x32_bf16 v[8:11], v[144:147], a[232:235], v[8:11]
    buffer_load_dword v47, v46, s[24:27], s49 offen sc1
    v_mfma_f32_16x16x32_bf16 v[8:11], v[152:155], a[236:239], v[8:11]
    buffer_load_dwordx4 v42, s[24:27], s35 offen offset:1024 sc1 lds
    v_mfma_f32_16x16x32_bf16 v[12:15], v[148:151], a[232:235], v[12:15]
    ds_read_b128 a[232:235], v36 offset:20480
    v_lshlrev_b32 v32, 16, v30
    v_mfma_f32_16x16x32_bf16 v[12:15], v[156:159], a[236:239], v[12:15]
    s_waitcnt lgkmcnt(7)
    ds_read_b128 a[236:239], v36 offset:21504
    v_and_b32 v34, s60, v30
    v_mfma_f32_16x16x32_bf16 v[8:11], v[160:163], a[208:211], v[8:11]
    buffer_load_dwordx4 v42, s[24:27], s35 offen offset:2048 sc1 lds
    v_mfma_f32_16x16x32_bf16 v[8:11], v[168:171], a[212:215], v[8:11]
    buffer_load_dwordx4 v42, s[24:27], s35 offen offset:3072 sc1 lds
    v_mfma_f32_16x16x32_bf16 v[12:15], v[164:167], a[208:211], v[12:15]
    s_addk_i32 m0, 4096
    ds_read_b128 a[208:211], v36 offset:22528
    v_fmac_f32 v33, v32, v4
    v_mfma_f32_16x16x32_bf16 v[12:15], v[172:175], a[212:215], v[12:15]
    s_waitcnt lgkmcnt(7)
    ds_read_b128 a[212:215], v36 offset:23552
    v_fmac_f32 v35, v34, v5
    v_mfma_f32_16x16x32_bf16 v[8:11], v[176:179], a[216:219], v[8:11]
    s_add_u32 s0, s0, s63
    ds_read_b64_tr_b16 a[22:23], v39 offset:20480
    ds_read_b64_tr_b16 a[24:25], v38 offset:24576
    v_mfma_f32_16x16x32_bf16 v[8:11], v[184:187], a[220:223], v[8:11]
    buffer_load_dwordx4 v42, s[24:27], s54 offen offset:0 sc1 lds
    v_mfma_f32_16x16x32_bf16 v[12:15], v[180:183], a[216:219], v[12:15]
    s_add_u32 s47, s46, s61
    ds_read_b128 a[216:219], v36 offset:24576
    v_cvt_pk_bf16_f32 v30, v33, v35
    v_mfma_f32_16x16x32_bf16 v[12:15], v[188:191], a[220:223], v[12:15]
    s_waitcnt lgkmcnt(7)
    ds_read_b128 a[220:223], v36 offset:25600
    v_add_u32 v36, 26624, v36
    v_mfma_f32_16x16x32_bf16 v[8:11], v[192:195], a[224:227], v[8:11]
    s_waitcnt vmcnt(15)
    buffer_store_dword v37, v45, s[24:27], s14 offen sc1
    v_mfma_f32_16x16x32_bf16 v[8:11], v[200:203], a[228:231], v[8:11]
    buffer_load_dwordx4 v42, s[24:27], s54 offen offset:1024 sc1 lds
    v_mfma_f32_16x16x32_bf16 v[12:15], v[196:199], a[224:227], v[12:15]
    s_mov_b32 m0, s34
    ds_read_b64_tr_b16 a[26:27], v38 offset:28672
    ds_read_b64_tr_b16 a[28:29], v39 offset:24576
    v_mfma_f32_16x16x32_bf16 v[12:15], v[204:207], a[228:231], v[12:15]
    s_waitcnt lgkmcnt(8)
    ds_read_b64_tr_b16 a[30:31], v39 offset:28672
    v_lshlrev_b32 v33, 16, v27
    v_mfma_f32_16x16x32_bf16 v[8:11], v[208:211], a[232:235], v[8:11]
    v_and_b32 v35, s60, v27
    ds_read_b128 v[24:27], v44 offset:0
    v_mfma_f32_16x16x32_bf16 v[8:11], v[216:219], a[236:239], v[8:11]
    buffer_load_dwordx4 v42, s[24:27], s0 offen offset:0 sc1 lds
    s_mov_b32 m0, s65
    v_lshlrev_b32 v32, 16, v31
    v_and_b32 v34, s60, v31
    v_fmac_f32 v33, v32, v6
    v_fmac_f32 v35, v34, v7
    v_cvt_pk_bf16_f32 v31, v33, v35
    buffer_store_dwordx4 v[28:31], v44, s[24:27], s1 offen sc1
    s_waitcnt vmcnt(10) lgkmcnt(0)
    s_barrier
    v_mfma_f32_16x16x32_bf16 v[12:15], v[212:215], a[232:235], v[12:15]
    buffer_load_dwordx4 v40, s[20:23], s47 offen lds
    v_mfma_f32_16x16x32_bf16 v[12:15], v[220:223], a[236:239], v[12:15]
    s_add_u32 s46, s47, s61
    ds_read_b128 a[224:227], v36 offset:0
    ds_read_b128 v[28:31], v43 offset:4096
    v_mfma_f32_16x16x32_bf16 v[8:11], v[224:227], a[208:211], v[8:11]
    s_addk_i32 s14, 4096
    ds_read_b128 a[228:231], v36 offset:1024
    v_lshlrev_b32 v33, 16, v24
    v_mfma_f32_16x16x32_bf16 v[8:11], v[232:235], a[212:215], v[8:11]
    s_add_u32 s1, s1, s63
    ds_read_b128 a[232:235], v36 offset:2048
    v_and_b32 v35, s60, v24
    v_mfma_f32_16x16x32_bf16 v[12:15], v[228:231], a[208:211], v[12:15]
    s_nop 0
    ds_read_b128 a[236:239], v36 offset:3072
    ds_read_b64_tr_b16 a[32:33], v38 offset:32768
    v_mfma_f32_16x16x32_bf16 v[12:15], v[236:239], a[212:215], v[12:15]
    s_nop 0
    ds_read_b128 a[208:211], v36 offset:4096
    ds_read_b64_tr_b16 a[34:35], v38 offset:36864
    v_mfma_f32_16x16x32_bf16 v[8:11], v[240:243], a[216:219], v[8:11]
    s_nop 0
    ds_read_b128 a[212:215], v36 offset:5120
    ds_read_b64_tr_b16 a[36:37], v39 offset:32768
    v_mfma_f32_16x16x32_bf16 v[8:11], v[248:251], a[220:223], v[8:11]
    buffer_load_dwordx4 v41, s[20:23], s47 offen offset:1024 lds
    v_mfma_f32_16x16x32_bf16 v[12:15], v[244:247], a[216:219], v[12:15]
    s_waitcnt lgkmcnt(8)
    ds_read_b128 a[216:219], v36 offset:6144
    v_lshlrev_b32 v32, 16, v28
    v_mfma_f32_16x16x32_bf16 v[12:15], v[252:255], a[220:223], v[12:15]
    s_waitcnt lgkmcnt(8)
    ds_read_b128 a[220:223], v36 offset:7168
    v_and_b32 v34, s60, v28
    v_mfma_f32_16x16x32_bf16 v[0:3], v[48:51], a[224:227], v[16:19]
    s_addk_i32 m0, 8192
    ds_read_b64_tr_b16 a[38:39], v39 offset:36864
    ds_read_b64_tr_b16 a[40:41], v38 offset:40960
    v_mfma_f32_16x16x32_bf16 v[0:3], v[56:59], a[228:231], v[0:3]
    buffer_load_dwordx4 v40, s[20:23], s46 offen lds
    v_mfma_f32_16x16x32_bf16 v[4:7], v[52:55], a[224:227], v[20:23]
    s_add_u32 s47, s46, s61
    ds_read_b128 a[224:227], v36 offset:8192
    v_fmac_f32 v33, v32, v8
    v_mfma_f32_16x16x32_bf16 v[4:7], v[60:63], a[228:231], v[4:7]
    s_waitcnt lgkmcnt(10)
    ds_read_b128 a[228:231], v36 offset:9216
    v_fmac_f32 v35, v34, v9
    v_mfma_f32_16x16x32_bf16 v[0:3], v[64:67], a[232:235], v[0:3]
    buffer_load_dwordx4 v41, s[20:23], s46 offen offset:1024 lds
    v_mfma_f32_16x16x32_bf16 v[0:3], v[72:75], a[236:239], v[0:3]
    s_addk_i32 m0, 8192
    ds_read_b64_tr_b16 a[42:43], v38 offset:45056
    ds_read_b64_tr_b16 a[44:45], v39 offset:40960
    v_mfma_f32_16x16x32_bf16 v[4:7], v[68:71], a[232:235], v[4:7]
    s_add_u32 s35, s35, s63
    ds_read_b128 a[232:235], v36 offset:10240
    v_cvt_pk_bf16_f32 v28, v33, v35
    v_mfma_f32_16x16x32_bf16 v[4:7], v[76:79], a[236:239], v[4:7]
    s_waitcnt lgkmcnt(10)
    ds_read_b128 a[236:239], v36 offset:11264
    v_lshlrev_b32 v33, 16, v25
    v_mfma_f32_16x16x32_bf16 v[0:3], v[80:83], a[208:211], v[0:3]
    buffer_load_dwordx4 v40, s[20:23], s47 offen lds
    v_mfma_f32_16x16x32_bf16 v[0:3], v[88:91], a[212:215], v[0:3]
    s_nop 0
    ds_read_b64_tr_b16 a[46:47], v39 offset:45056
    ds_read_b64_tr_b16 a[48:49], v38 offset:49152
    v_mfma_f32_16x16x32_bf16 v[4:7], v[84:87], a[208:211], v[4:7]
    ds_read_b128 a[208:211], v36 offset:12288
    v_and_b32 v35, s60, v25
    v_mfma_f32_16x16x32_bf16 v[4:7], v[92:95], a[212:215], v[4:7]
    s_waitcnt lgkmcnt(11)
    ds_read_b128 a[212:215], v36 offset:13312
    v_lshlrev_b32 v32, 16, v29
    v_mfma_f32_16x16x32_bf16 v[0:3], v[96:99], a[216:219], v[0:3]
    buffer_load_dwordx4 v41, s[20:23], s47 offen offset:1024 lds
    v_mfma_f32_16x16x32_bf16 v[0:3], v[104:107], a[220:223], v[0:3]
    s_waitcnt vmcnt(14)
    v_cmp_ne_u32 vcc, s45, v47
    s_cbranch_vccnz L_slow12
L_back12:
    v_mfma_f32_16x16x32_bf16 v[4:7], v[100:103], a[216:219], v[4:7]
    s_mov_b32 m0, s67
    ds_read_b128 a[216:219], v36 offset:14336
    v_and_b32 v34, s60, v29
    v_mfma_f32_16x16x32_bf16 v[4:7], v[108:111], a[220:223], v[4:7]
    s_waitcnt lgkmcnt(9)
    ds_read_b128 a[220:223], v36 offset:15360
    v_fmac_f32 v33, v32, v10
    v_mfma_f32_16x16x32_bf16 v[0:3], v[112:115], a[224:227], v[0:3]
    buffer_load_dwordx4 v42, s[24:27], s35 offen offset:0 sc1 lds
    v_mfma_f32_16x16x32_bf16 v[0:3], v[120:123], a[228:231], v[0:3]
    s_addk_i32 s49, 4096
    ds_read_b64_tr_b16 a[50:51], v38 offset:53248
    ds_read_b64_tr_b16 a[52:53], v39 offset:49152
    v_mfma_f32_16x16x32_bf16 v[4:7], v[116:119], a[224:227], v[4:7]
    s_add_u32 s54, s35, s64
    ds_read_b128 a[224:227], v36 offset:16384
    v_fmac_f32 v35, v34, v11
    v_mfma_f32_16x16x32_bf16 v[4:7], v[124:127], a[228:231], v[4:7]
    s_waitcnt lgkmcnt(9)
    ds_read_b128 a[228:231], v36 offset:17408
    v_cvt_pk_bf16_f32 v29, v33, v35
    v_mfma_f32_16x16x32_bf16 v[0:3], v[128:131], a[232:235], v[0:3]
    buffer_load_dwordx4 v42, s[24:27], s35 offen offset:1024 sc1 lds
    v_mfma_f32_16x16x32_bf16 v[0:3], v[136:139], a[236:239], v[0:3]
    buffer_load_dword v47, v46, s[24:27], s49 offen sc1
    v_mfma_f32_16x16x32_bf16 v[4:7], v[132:135], a[232:235], v[4:7]
    ds_read_b128 a[232:235], v36 offset:18432
    v_lshlrev_b32 v33, 16, v26
    v_mfma_f32_16x16x32_bf16 v[4:7], v[140:143], a[236:239], v[4:7]
    s_waitcnt lgkmcnt(7)
    ds_read_b128 a[236:239], v36 offset:19456
    v_and_b32 v35, s60, v26
    v_mfma_f32_16x16x32_bf16 v[0:3], v[144:147], a[208:211], v[0:3]
    buffer_load_dwordx4 v42, s[24:27], s35 offen offset:2048 sc1 lds
    v_mfma_f32_16x16x32_bf16 v[0:3], v[152:155], a[212:215], v[0:3]
    s_nop 0
    ds_read_b64_tr_b16 a[54:55], v39 offset:53248
    ds_read_b64_tr_b16 a[56:57], v38 offset:57344
    v_mfma_f32_16x16x32_bf16 v[4:7], v[148:151], a[208:211], v[4:7]
    ds_read_b128 a[208:211], v36 offset:20480
    v_lshlrev_b32 v32, 16, v30
    v_mfma_f32_16x16x32_bf16 v[4:7], v[156:159], a[212:215], v[4:7]
    s_waitcnt lgkmcnt(9)
    ds_read_b128 a[212:215], v36 offset:21504
    v_and_b32 v34, s60, v30
    v_mfma_f32_16x16x32_bf16 v[0:3], v[160:163], a[216:219], v[0:3]
    buffer_load_dwordx4 v42, s[24:27], s35 offen offset:3072 sc1 lds
    v_mfma_f32_16x16x32_bf16 v[0:3], v[168:171], a[220:223], v[0:3]
    s_addk_i32 m0, 4096
    ds_read_b64_tr_b16 a[58:59], v38 offset:61440
    ds_read_b64_tr_b16 a[60:61], v39 offset:57344
    v_mfma_f32_16x16x32_bf16 v[4:7], v[164:167], a[216:219], v[4:7]
    s_add_u32 s0, s0, s63
    ds_read_b128 a[216:219], v36 offset:22528
    v_fmac_f32 v33, v32, v12
    v_mfma_f32_16x16x32_bf16 v[4:7], v[172:175], a[220:223], v[4:7]
    s_waitcnt lgkmcnt(9)
    ds_read_b128 a[220:223], v36 offset:23552
    v_fmac_f32 v35, v34, v13
    v_mfma_f32_16x16x32_bf16 v[0:3], v[176:179], a[224:227], v[0:3]
    buffer_load_dwordx4 v42, s[24:27], s54 offen offset:0 sc1 lds
    v_mfma_f32_16x16x32_bf16 v[0:3], v[184:187], a[228:231], v[0:3]
    s_add_u32 s46, s47, s61
    ds_read_b64_tr_b16 a[62:63], v39 offset:61440
L_page4:
    s_cbranch_execz L_walk_back
    v_cvt_pk_bf16_f32 v30, v33, v35
    v_mfma_f32_16x16x32_bf16 v[4:7], v[180:183], a[224:227], v[4:7]
    ds_read_b128 a[224:227], v36 offset:24576
    v_lshlrev_b32 v33, 16, v27
    v_mfma_f32_16x16x32_bf16 v[4:7], v[188:191], a[228:231], v[4:7]
    s_waitcnt lgkmcnt(10)
    ds_read_b128 a[228:231], v36 offset:25600
    v_add_u32 v36, 26624, v36
    v_mfma_f32_16x16x32_bf16 v[0:3], v[192:195], a[232:235], v[0:3]
    s_waitcnt vmcnt(12)
    buffer_store_dword v37, v45, s[24:27], s14 offen sc1
    v_mfma_f32_16x16x32_bf16 v[0:3], v[200:203], a[236:239], v[0:3]
    buffer_load_dwordx4 v42, s[24:27], s54 offen offset:1024 sc1 lds
    v_mfma_f32_16x16x32_bf16 v[4:7], v[196:199], a[232:235], v[4:7]
    v_and_b32 v35, s60, v27
    ds_read_b128 v[24:27], v44 offset:26624
    s_mov_b32 m0, s32
    v_mfma_f32_16x16x32_bf16 v[4:7], v[204:207], a[236:239], v[4:7]
    s_waitcnt lgkmcnt(8)
    v_lshlrev_b32 v32, 16, v31
    v_and_b32 v34, s60, v31
    v_mfma_f32_16x16x32_bf16 v[0:3], v[208:211], a[208:211], v[0:3]
    v_fmac_f32 v33, v32, v14
    v_fmac_f32 v35, v34, v15
    v_mfma_f32_16x16x32_bf16 v[0:3], v[216:219], a[212:215], v[0:3]
    buffer_load_dwordx4 v42, s[24:27], s0 offen offset:0 sc1 lds
    s_mov_b32 m0, s66
    v_cvt_pk_bf16_f32 v31, v33, v35
    buffer_store_dwordx4 v[28:31], v44, s[24:27], s1 offen sc1
    s_waitcnt vmcnt(10) lgkmcnt(0)
    s_barrier
    v_mfma_f32_16x16x32_bf16 v[4:7], v[212:215], a[208:211], v[4:7]
    buffer_load_dwordx4 v40, s[20:23], s46 offen lds
    v_mfma_f32_16x16x32_bf16 v[4:7], v[220:223], a[212:215], v[4:7]
    s_add_u32 s47, s46, s61
    ds_read_b128 a[232:235], v36 offset:0
    ds_read_b128 v[28:31], v43 offset:8192
    v_mfma_f32_16x16x32_bf16 v[0:3], v[224:227], a[216:219], v[0:3]
    s_addk_i32 s14, 4096
    ds_read_b128 a[236:239], v36 offset:1024
    v_lshlrev_b32 v33, 16, v24
    v_mfma_f32_16x16x32_bf16 v[0:3], v[232:235], a[220:223], v[0:3]
    s_add_u32 s1, s1, s63
    ds_read_b128 a[208:211], v36 offset:2048
    v_and_b32 v35, s60, v24
    v_mfma_f32_16x16x32_bf16 v[4:7], v[228:231], a[216:219], v[4:7]
    s_nop 0
    ds_read_b128 a[212:215], v36 offset:3072
    ds_read_b64_tr_b16 a[64:65], v38 offset:0
    v_mfma_f32_16x16x32_bf16 v[4:7], v[236:239], a[220:223], v[4:7]
    s_nop 0
    ds_read_b128 a[216:219], v36 offset:4096
    ds_read_b64_tr_b16 a[66:67], v38 offset:4096
    v_mfma_f32_16x16x32_bf16 v[0:3], v[240:243], a[224:227], v[0:3]
    s_nop 0
    ds_read_b128 a[220:223], v36 offset:5120
    ds_read_b64_tr_b16 a[68:69], v39 offset:0
    v_mfma_f32_16x16x32_bf16 v[0:3], v[248:251], a[228:231], v[0:3]
    buffer_load_dwordx4 v41, s[20:23], s46 offen offset:1024 lds
    v_mfma_f32_16x16x32_bf16 v[4:7], v[244:247], a[224:227], v[4:7]
    s_waitcnt lgkmcnt(8)
    ds_read_b128 a[224:227], v36 offset:6144
    v_lshlrev_b32 v32, 16, v28
    v_mfma_f32_16x16x32_bf16 v[4:7], v[252:255], a[228:231], v[4:7]
    s_waitcnt lgkmcnt(8)
    ds_read_b128 a[228:231], v36 offset:7168
    v_and_b32 v34, s60, v28
    v_mfma_f32_16x16x32_bf16 v[8:11], v[48:51], a[232:235], v[16:19]
    s_addk_i32 m0, 8192
    ds_read_b64_tr_b16 a[70:71], v39 offset:4096
    ds_read_b64_tr_b16 a[72:73], v38 offset:8192
    v_mfma_f32_16x16x32_bf16 v[8:11], v[56:59], a[236:239], v[8:11]
    buffer_load_dwordx4 v40, s[20:23], s47 offen lds
    v_mfma_f32_16x16x32_bf16 v[12:15], v[52:55], a[232:235], v[20:23]
    s_add_u32 s46, s47, s61
    ds_read_b128 a[232:235], v36 offset:8192
    v_fmac_f32 v33, v32, v0
    v_mfma_f32_16x16x32_bf16 v[12:15], v[60:63], a[236:239], v[12:15]
    s_waitcnt lgkmcnt(10)
    ds_read_b128 a[236:239], v36 offset:9216
    v_fmac_f32 v35, v34, v1
    v_mfma_f32_16x16x32_bf16 v[8:11], v[64:67], a[208:211], v[8:11]
    buffer_load_dwordx4 v41, s[20:23], s47 offen offset:1024 lds
    v_mfma_f32_16x16x32_bf16 v[8:11], v[72:75], a[212:215], v[8:11]
    s_addk_i32 m0, 8192
    ds_read_b64_tr_b16 a[74:75], v38 offset:12288
    ds_read_b64_tr_b16 a[76:77], v39 offset:8192
    v_mfma_f32_16x16x32_bf16 v[12:15], v[68:71], a[208:211], v[12:15]
    s_add_u32 s35, s35, s63
    ds_read_b128 a[208:211], v36 offset:10240
    v_cvt_pk_bf16_f32 v28, v33, v35
    v_mfma_f32_16x16x32_bf16 v[12:15], v[76:79], a[212:215], v[12:15]
    s_waitcnt lgkmcnt(10)
    ds_read_b128 a[212:215], v36 offset:11264
    v_lshlrev_b32 v33, 16, v25
    v_mfma_f32_16x16x32_bf16 v[8:11], v[80:83], a[216:219], v[8:11]
    buffer_load_dwordx4 v40, s[20:23], s46 offen lds
    v_mfma_f32_16x16x32_bf16 v[8:11], v[88:91], a[220:223], v[8:11]
    s_nop 0
    ds_read_b64_tr_b16 a[78:79], v39 offset:12288
    ds_read_b64_tr_b16 a[80:81], v38 offset:16384
    v_mfma_f32_16x16x32_bf16 v[12:15], v[84:87], a[216:219], v[12:15]
    ds_read_b128 a[216:219], v36 offset:12288
    v_and_b32 v35, s60, v25
    v_mfma_f32_16x16x32_bf16 v[12:15], v[92:95], a[220:223], v[12:15]
    s_waitcnt lgkmcnt(11)
    ds_read_b128 a[220:223], v36 offset:13312
    v_lshlrev_b32 v32, 16, v29
    v_mfma_f32_16x16x32_bf16 v[8:11], v[96:99], a[224:227], v[8:11]
    buffer_load_dwordx4 v41, s[20:23], s46 offen offset:1024 lds
    v_mfma_f32_16x16x32_bf16 v[8:11], v[104:107], a[228:231], v[8:11]
    s_waitcnt vmcnt(13)
    v_cmp_ne_u32 vcc, s45, v47
    s_cbranch_vccnz L_slow13
L_back13:
    v_mfma_f32_16x16x32_bf16 v[12:15], v[100:103], a[224:227], v[12:15]
    s_mov_b32 m0, s68
    ds_read_b128 a[224:227], v36 offset:14336
    v_and_b32 v34, s60, v29
    v_mfma_f32_16x16x32_bf16 v[12:15], v[108:111], a[228:231], v[12:15]
    s_waitcnt lgkmcnt(9)
    ds_read_b128 a[228:231], v36 offset:15360
    v_fmac_f32 v33, v32, v2
    v_mfma_f32_16x16x32_bf16 v[8:11], v[112:115], a[232:235], v[8:11]
    buffer_load_dwordx4 v42, s[24:27], s35 offen offset:0 sc1 lds
    v_mfma_f32_16x16x32_bf16 v[8:11], v[120:123], a[236:239], v[8:11]
    s_addk_i32 s49, 4096
    ds_read_b64_tr_b16 a[82:83], v38 offset:20480
    ds_read_b64_tr_b16 a[84:85], v39 offset:16384
    v_mfma_f32_16x16x32_bf16 v[12:15], v[116:119], a[232:235], v[12:15]
    s_add_u32 s54, s35, s64
    ds_read_b128 a[232:235], v36 offset:16384
    v_fmac_f32 v35, v34, v3
    v_mfma_f32_16x16x32_bf16 v[12:15], v[124:127], a[236:239], v[12:15]
    s_waitcnt lgkmcnt(9)
    ds_read_b128 a[236:239], v36 offset:17408
    v_cvt_pk_bf16_f32 v29, v33, v35
    v_mfma_f32_16x16x32_bf16 v[8:11], v[128:131], a[208:211], v[8:11]
    buffer_load_dwordx4 v42, s[24:27], s35 offen offset:1024 sc1 lds
    v_mfma_f32_16x16x32_bf16 v[8:11], v[136:139], a[212:215], v[8:11]
    buffer_load_dword v47, v46, s[24:27], s49 offen sc1
    v_mfma_f32_16x16x32_bf16 v[12:15], v[132:135], a[208:211], v[12:15]
    ds_read_b128 a[208:211], v36 offset:18432
    v_lshlrev_b32 v33, 16, v26
    v_mfma_f32_16x16x32_bf16 v[12:15], v[140:143], a[212:215], v[12:15]
    s_waitcnt lgkmcnt(7)
    ds_read_b128 a[212:215], v36 offset:19456
    v_and_b32 v35, s60, v26
    v_mfma_f32_16x16x32_bf16 v[8:11], v[144:147], a[216:219], v[8:11]
    buffer_load_dwordx4 v42, s[24:27], s35 offen offset:2048 sc1 lds
    v_mfma_f32_16x16x32_bf16 v[8:11], v[152:155], a[220:223], v[8:11]
    ds_read_b64_tr_b16 a[86:87], v39 offset:20480
    v_lshlrev_b32 v32, 16, v30
    v_mfma_f32_16x16x32_bf16 v[12:15], v[148:151], a[216:219], v[12:15]
    ds_read_b128 a[216:219], v36 offset:20480
    v_and_b32 v34, s60, v30
    v_mfma_f32_16x16x32_bf16 v[12:15], v[156:159], a[220:223], v[12:15]
    s_waitcnt lgkmcnt(8)
    ds_read_b128 a[220:223], v36 offset:21504
    v_fmac_f32 v33, v32, v4
    v_mfma_f32_16x16x32_bf16 v[8:11], v[160:163], a[224:227], v[8:11]
    buffer_load_dwordx4 v42, s[24:27], s35 offen offset:3072 sc1 lds
    v_mfma_f32_16x16x32_bf16 v[8:11], v[168:171], a[228:231], v[8:11]
    s_addk_i32 m0, 4096
    v_fmac_f32 v35, v34, v5
    v_cvt_pk_bf16_f32 v30, v33, v35
    v_mfma_f32_16x16x32_bf16 v[12:15], v[164:167], a[224:227], v[12:15]
    s_add_u32 s0, s0, s63
    ds_read_b128 a[224:227], v36 offset:22528
    v_lshlrev_b32 v33, 16, v27
    v_mfma_f32_16x16x32_bf16 v[12:15], v[172:175], a[228:231], v[12:15]
    s_waitcnt lgkmcnt(6)
    ds_read_b128 a[228:231], v36 offset:23552
    v_and_b32 v35, s60, v27
    v_mfma_f32_16x16x32_bf16 v[8:11], v[176:179], a[232:235], v[8:11]
    buffer_load_dwordx4 v42, s[24:27], s54 offen offset:0 sc1 lds
    v_mfma_f32_16x16x32_bf16 v[8:11], v[184:187], a[236:239], v[8:11]
    s_add_u32 s47, s46, s61
    ds_read_b128 v[24:27], v44 offset:53248
    v_lshlrev_b32 v32, 16, v31
    v_mfma_f32_16x16x32_bf16 v[12:15], v[180:183], a[232:235], v[12:15]
    ds_read_b128 a[232:235], v36 offset:24576
    v_and_b32 v34, s60, v31
    v_mfma_f32_16x16x32_bf16 v[12:15], v[188:191], a[236:239], v[12:15]
    s_waitcnt lgkmcnt(7)
    ds_read_b128 a[236:239], v36 offset:25600
    v_subrev_u32 v36, 53248, v36
    v_mfma_f32_16x16x32_bf16 v[8:11], v[192:195], a[208:211], v[8:11]
    s_waitcnt vmcnt(12)
    buffer_store_dword v37, v45, s[24:27], s14 offen sc1
    v_mfma_f32_16x16x32_bf16 v[8:11], v[200:203], a[212:215], v[8:11]
    buffer_load_dwordx4 v42, s[24:27], s54 offen offset:1024 sc1 lds
    v_mfma_f32_16x16x32_bf16 v[12:15], v[196:199], a[208:211], v[12:15]
    s_mov_b32 m0, s33
    v_fmac_f32 v33, v32, v6
    v_fmac_f32 v35, v34, v7
    v_mfma_f32_16x16x32_bf16 v[12:15], v[204:207], a[212:215], v[12:15]
    s_waitcnt lgkmcnt(5)
    v_cvt_pk_bf16_f32 v31, v33, v35
    v_mfma_f32_16x16x32_bf16 v[8:11], v[208:211], a[216:219], v[8:11]
    buffer_store_dwordx4 v[28:31], v44, s[24:27], s1 offen sc1
    v_mfma_f32_16x16x32_bf16 v[8:11], v[216:219], a[220:223], v[8:11]
    buffer_load_dwordx4 v42, s[24:27], s0 offen offset:0 sc1 lds
    s_mov_b32 m0, s65
    s_waitcnt vmcnt(10) lgkmcnt(0)
    s_barrier
    v_mfma_f32_16x16x32_bf16 v[12:15], v[212:215], a[216:219], v[12:15]
    buffer_load_dwordx4 v40, s[20:23], s47 offen lds
    v_mfma_f32_16x16x32_bf16 v[12:15], v[220:223], a[220:223], v[12:15]
    s_add_u32 s46, s47, s61
    ds_read_b128 a[208:211], v36 offset:0
    ds_read_b128 v[28:31], v43 offset:12288
    v_mfma_f32_16x16x32_bf16 v[8:11], v[224:227], a[224:227], v[8:11]
    s_addk_i32 s14, 4096
    ds_read_b128 a[212:215], v36 offset:1024
    v_lshlrev_b32 v33, 16, v24
    v_mfma_f32_16x16x32_bf16 v[8:11], v[232:235], a[228:231], v[8:11]
    s_add_u32 s1, s1, s63
    ds_read_b128 a[216:219], v36 offset:2048
    v_and_b32 v35, s60, v24
    v_mfma_f32_16x16x32_bf16 v[12:15], v[228:231], a[224:227], v[12:15]
    s_nop 0
    ds_read_b128 a[220:223], v36 offset:3072
    ds_read_b64_tr_b16 a[88:89], v38 offset:32768
    v_mfma_f32_16x16x32_bf16 v[12:15], v[236:239], a[228:231], v[12:15]
    s_nop 0
    ds_read_b128 a[224:227], v36 offset:4096
    ds_read_b64_tr_b16 a[90:91], v38 offset:36864
    v_mfma_f32_16x16x32_bf16 v[8:11], v[240:243], a[232:235], v[8:11]
    s_nop 0
    ds_read_b128 a[228:231], v36 offset:5120
    ds_read_b64_tr_b16 a[92:93], v39 offset:32768
    v_mfma_f32_16x16x32_bf16 v[8:11], v[248:251], a[236:239], v[8:11]
    buffer_load_dwordx4 v41, s[20:23], s47 offen offset:1024 lds
    v_mfma_f32_16x16x32_bf16 v[12:15], v[244:247], a[232:235], v[12:15]
    s_waitcnt lgkmcnt(8)
    ds_read_b128 a[232:235], v36 offset:6144
    v_lshlrev_b32 v32, 16, v28
    v_mfma_f32_16x16x32_bf16 v[12:15], v[252:255], a[236:239], v[12:15]
    s_waitcnt lgkmcnt(8)
    ds_read_b128 a[236:239], v36 offset:7168
    v_and_b32 v34, s60, v28
    v_mfma_f32_16x16x32_bf16 v[0:3], v[48:51], a[208:211], v[16:19]
    s_addk_i32 m0, 8192
    ds_read_b64_tr_b16 a[94:95], v39 offset:36864
    ds_read_b64_tr_b16 a[96:97], v38 offset:40960
    v_mfma_f32_16x16x32_bf16 v[0:3], v[56:59], a[212:215], v[0:3]
    buffer_load_dwordx4 v40, s[20:23], s46 offen lds
    v_mfma_f32_16x16x32_bf16 v[4:7], v[52:55], a[208:211], v[20:23]
    s_add_u32 s47, s46, s61
    ds_read_b128 a[208:211], v36 offset:8192
    v_fmac_f32 v33, v32, v8
    v_mfma_f32_16x16x32_bf16 v[4:7], v[60:63], a[212:215], v[4:7]
    s_waitcnt lgkmcnt(10)
    ds_read_b128 a[212:215], v36 offset:9216
    v_fmac_f32 v35, v34, v9
    v_mfma_f32_16x16x32_bf16 v[0:3], v[64:67], a[216:219], v[0:3]
    buffer_load_dwordx4 v41, s[20:23], s46 offen offset:1024 lds
    v_mfma_f32_16x16x32_bf16 v[0:3], v[72:75], a[220:223], v[0:3]
    s_addk_i32 m0, 8192
    ds_read_b64_tr_b16 a[98:99], v38 offset:45056
    ds_read_b64_tr_b16 a[100:101], v39 offset:40960
    v_mfma_f32_16x16x32_bf16 v[4:7], v[68:71], a[216:219], v[4:7]
    s_add_u32 s35, s35, s63
    ds_read_b128 a[216:219], v36 offset:10240
    v_cvt_pk_bf16_f32 v28, v33, v35
    v_mfma_f32_16x16x32_bf16 v[4:7], v[76:79], a[220:223], v[4:7]
    s_waitcnt lgkmcnt(10)
    ds_read_b128 a[220:223], v36 offset:11264
    v_lshlrev_b32 v33, 16, v25
    v_mfma_f32_16x16x32_bf16 v[0:3], v[80:83], a[224:227], v[0:3]
    buffer_load_dwordx4 v40, s[20:23], s47 offen lds
    v_mfma_f32_16x16x32_bf16 v[0:3], v[88:91], a[228:231], v[0:3]
    s_nop 0
    ds_read_b64_tr_b16 a[102:103], v39 offset:45056
    ds_read_b64_tr_b16 a[104:105], v38 offset:49152
    v_mfma_f32_16x16x32_bf16 v[4:7], v[84:87], a[224:227], v[4:7]
    ds_read_b128 a[224:227], v36 offset:12288
    v_and_b32 v35, s60, v25
    v_mfma_f32_16x16x32_bf16 v[4:7], v[92:95], a[228:231], v[4:7]
    s_waitcnt lgkmcnt(11)
    ds_read_b128 a[228:231], v36 offset:13312
    v_lshlrev_b32 v32, 16, v29
    v_mfma_f32_16x16x32_bf16 v[0:3], v[96:99], a[232:235], v[0:3]
    buffer_load_dwordx4 v41, s[20:23], s47 offen offset:1024 lds
    v_mfma_f32_16x16x32_bf16 v[0:3], v[104:107], a[236:239], v[0:3]
    s_waitcnt vmcnt(13)
    v_cmp_ne_u32 vcc, s45, v47
    s_cbranch_vccnz L_slow14
L_back14:
    v_mfma_f32_16x16x32_bf16 v[4:7], v[100:103], a[232:235], v[4:7]
    s_mov_b32 m0, s69
    ds_read_b128 a[232:235], v36 offset:14336
    v_and_b32 v34, s60, v29
    v_mfma_f32_16x16x32_bf16 v[4:7], v[108:111], a[236:239], v[4:7]
    s_waitcnt lgkmcnt(9)
    ds_read_b128 a[236:239], v36 offset:15360
    v_fmac_f32 v33, v32, v10
    v_mfma_f32_16x16x32_bf16 v[0:3], v[112:115], a[208:211], v[0:3]
    buffer_load_dwordx4 v42, s[24:27], s35 offen offset:0 sc1 lds
    v_mfma_f32_16x16x32_bf16 v[0:3], v[120:123], a[212:215], v[0:3]
    s_addk_i32 s49, 4096
    ds_read_b64_tr_b16 a[106:107], v38 offset:53248
    ds_read_b64_tr_b16 a[108:109], v39 offset:49152
    v_mfma_f32_16x16x32_bf16 v[4:7], v[116:119], a[208:211], v[4:7]
    s_add_u32 s54, s35, s64
    ds_read_b128 a[208:211], v36 offset:16384
    v_fmac_f32 v35, v34, v11
    v_mfma_f32_16x16x32_bf16 v[4:7], v[124:127], a[212:215], v[4:7]
    s_waitcnt lgkmcnt(9)
    ds_read_b128 a[212:215], v36 offset:17408
    v_cvt_pk_bf16_f32 v29, v33, v35
    v_mfma_f32_16x16x32_bf16 v[0:3], v[128:131], a[216:219], v[0:3]
    buffer_load_dwordx4 v42, s[24:27], s35 offen offset:1024 sc1 lds
    v_mfma_f32_16x16x32_bf16 v[0:3], v[136:139], a[220:223], v[0:3]
    buffer_load_dword v47, v46, s[24:27], s49 offen sc1
    v_mfma_f32_16x16x32_bf16 v[4:7], v[132:135], a[216:219], v[4:7]
    ds_read_b128 a[216:219], v36 offset:18432
    v_lshlrev_b32 v33, 16, v26
    v_mfma_f32_16x16x32_bf16 v[4:7], v[140:143], a[220:223], v[4:7]
    s_waitcnt lgkmcnt(7)
    ds_read_b128 a[220:223], v36 offset:19456
    v_and_b32 v35, s60, v26
    v_mfma_f32_16x16x32_bf16 v[0:3], v[144:147], a[224:227], v[0:3]
    buffer_load_dwordx4 v42, s[24:27], s35 offen offset:2048 sc1 lds
    v_mfma_f32_16x16x32_bf16 v[0:3], v[152:155], a[228:231], v[0:3]
    ds_read_b64_tr_b16 a[110:111], v39 offset:53248
    v_lshlrev_b32 v32, 16, v30
    v_mfma_f32_16x16x32_bf16 v[4:7], v[148:151], a[224:227], v[4:7]
    ds_read_b128 a[224:227], v36 offset:20480
    v_and_b32 v34, s60, v30
    v_mfma_f32_16x16x32_bf16 v[4:7], v[156:159], a[228:231], v[4:7]
    s_waitcnt lgkmcnt(8)
    ds_read_b128 a[228:231], v36 offset:21504
    v_fmac_f32 v33, v32, v12
    v_mfma_f32_16x16x32_bf16 v[0:3], v[160:163], a[232:235], v[0:3]
    buffer_load_dwordx4 v42, s[24:27], s35 offen offset:3072 sc1 lds
    v_mfma_f32_16x16x32_bf16 v[0:3], v[168:171], a[236:239], v[0:3]
    s_addk_i32 m0, 4096
    v_fmac_f32 v35, v34, v13
    v_cvt_pk_bf16_f32 v30, v33, v35
    v_mfma_f32_16x16x32_bf16 v[4:7], v[164:167], a[232:235], v[4:7]
    s_add_u32 s0, s0, s63
    ds_read_b128 a[232:235], v36 offset:22528
    v_lshlrev_b32 v33, 16, v27
    v_mfma_f32_16x16x32_bf16 v[4:7], v[172:175], a[236:239], v[4:7]
    s_waitcnt lgkmcnt(6)
    ds_read_b128 a[236:239], v36 offset:23552
    v_and_b32 v35, s60, v27
    v_mfma_f32_16x16x32_bf16 v[0:3], v[176:179], a[208:211], v[0:3]
    buffer_load_dwordx4 v42, s[24:27], s54 offen offset:0 sc1 lds
    v_mfma_f32_16x16x32_bf16 v[0:3], v[184:187], a[212:215], v[0:3]
    s_add_u32 s46, s47, s61
    ds_read_b128 v[24:27], v44 offset:0
    v_lshlrev_b32 v32, 16, v31
    v_mfma_f32_16x16x32_bf16 v[4:7], v[180:183], a[208:211], v[4:7]
    ds_read_b128 a[208:211], v36 offset:24576
    v_and_b32 v34, s60, v31
    v_mfma_f32_16x16x32_bf16 v[4:7], v[188:191], a[212:215], v[4:7]
    s_waitcnt lgkmcnt(7)
    ds_read_b128 a[212:215], v36 offset:25600
    v_add_u32 v36, 26624, v36
    v_mfma_f32_16x16x32_bf16 v[0:3], v[192:195], a[216:219], v[0:3]
    s_waitcnt vmcnt(13)
    buffer_store_dword v37, v45, s[24:27], s14 offen sc1
    v_mfma_f32_16x16x32_bf16 v[0:3], v[200:203], a[220:223], v[0:3]
    buffer_load_dwordx4 v42, s[24:27], s54 offen offset:1024 sc1 lds
    v_mfma_f32_16x16x32_bf16 v[4:7], v[196:199], a[216:219], v[4:7]
    s_mov_b32 m0, s34
    v_fmac_f32 v33, v32, v14
    v_fmac_f32 v35, v34, v15
    v_mfma_f32_16x16x32_bf16 v[4:7], v[204:207], a[220:223], v[4:7]
    s_waitcnt lgkmcnt(5)
    v_cvt_pk_bf16_f32 v31, v33, v35
    v_mfma_f32_16x16x32_bf16 v[0:3], v[208:211], a[224:227], v[0:3]
    buffer_store_dwordx4 v[28:31], v44, s[24:27], s1 offen sc1
    v_mfma_f32_16x16x32_bf16 v[0:3], v[216:219], a[228:231], v[0:3]
    buffer_load_dwordx4 v42, s[24:27], s0 offen offset:0 sc1 lds
    s_mov_b32 m0, s66
    s_waitcnt vmcnt(10) lgkmcnt(0)
    s_barrier
    v_mfma_f32_16x16x32_bf16 v[4:7], v[212:215], a[224:227], v[4:7]
    buffer_load_dwordx4 v40, s[20:23], s46 offen lds
    v_mfma_f32_16x16x32_bf16 v[4:7], v[220:223], a[228:231], v[4:7]
    s_add_u32 s47, s46, s61
    ds_read_b128 a[216:219], v36 offset:0
    v_accvgpr_read_b32 v28, a240
    v_mfma_f32_16x16x32_bf16 v[0:3], v[224:227], a[232:235], v[0:3]
    s_addk_i32 s14, 4096
    ds_read_b128 a[220:223], v36 offset:1024
    v_accvgpr_read_b32 v29, a241
    v_mfma_f32_16x16x32_bf16 v[0:3], v[232:235], a[236:239], v[0:3]
    s_add_u32 s1, s1, s63
    ds_read_b128 a[224:227], v36 offset:2048
    v_accvgpr_read_b32 v30, a242
    v_mfma_f32_16x16x32_bf16 v[4:7], v[228:231], a[232:235], v[4:7]
    ds_read_b128 a[228:231], v36 offset:3072
    v_accvgpr_read_b32 v31, a243
    v_mfma_f32_16x16x32_bf16 v[4:7], v[236:239], a[236:239], v[4:7]
    ds_read_b128 a[232:235], v36 offset:4096
    v_lshlrev_b32 v33, 16, v24
    v_mfma_f32_16x16x32_bf16 v[0:3], v[240:243], a[208:211], v[0:3]
    ds_read_b128 a[236:239], v36 offset:5120
    v_and_b32 v35, s60, v24
    v_mfma_f32_16x16x32_bf16 v[0:3], v[248:251], a[212:215], v[0:3]
    buffer_load_dwordx4 v41, s[20:23], s46 offen offset:1024 lds
    v_mfma_f32_16x16x32_bf16 v[4:7], v[244:247], a[208:211], v[4:7]
    s_addk_i32 m0, 8192
    ds_read_b128 a[208:211], v36 offset:6144
    v_lshlrev_b32 v32, 16, v28
    v_mfma_f32_16x16x32_bf16 v[4:7], v[252:255], a[212:215], v[4:7]
    s_waitcnt lgkmcnt(5)
    ds_read_b128 a[212:215], v36 offset:7168
    v_and_b32 v34, s60, v28
    v_mfma_f32_16x16x32_bf16 v[8:11], v[48:51], a[216:219], v[16:19]
    buffer_load_dwordx4 v40, s[20:23], s47 offen lds
    v_mfma_f32_16x16x32_bf16 v[8:11], v[56:59], a[220:223], v[8:11]
    s_add_u32 s46, s47, s61
    ds_read_b64_tr_b16 a[112:113], v38 offset:0
    ds_read_b64_tr_b16 a[114:115], v38 offset:4096
    v_mfma_f32_16x16x32_bf16 v[12:15], v[52:55], a[216:219], v[20:23]
    s_add_u32 s35, s35, s63
    ds_read_b128 a[216:219], v36 offset:8192
    v_fmac_f32 v33, v32, v0
    v_mfma_f32_16x16x32_bf16 v[12:15], v[60:63], a[220:223], v[12:15]
    s_waitcnt lgkmcnt(7)
    ds_read_b128 a[220:223], v36 offset:9216
    v_fmac_f32 v35, v34, v1
    v_mfma_f32_16x16x32_bf16 v[8:11], v[64:67], a[224:227], v[8:11]
    buffer_load_dwordx4 v41, s[20:23], s47 offen offset:1024 lds
    v_mfma_f32_16x16x32_bf16 v[8:11], v[72:75], a[228:231], v[8:11]
    s_addk_i32 m0, 8192
    ds_read_b64_tr_b16 a[116:117], v39 offset:0
    ds_read_b64_tr_b16 a[118:119], v39 offset:4096
    v_mfma_f32_16x16x32_bf16 v[12:15], v[68:71], a[224:227], v[12:15]
    ds_read_b128 a[224:227], v36 offset:10240
    v_cvt_pk_bf16_f32 v28, v33, v35
    v_mfma_f32_16x16x32_bf16 v[12:15], v[76:79], a[228:231], v[12:15]
    s_waitcnt lgkmcnt(9)
    ds_read_b128 a[228:231], v36 offset:11264
    v_lshlrev_b32 v33, 16, v25
    v_mfma_f32_16x16x32_bf16 v[8:11], v[80:83], a[232:235], v[8:11]
    buffer_load_dwordx4 v40, s[20:23], s46 offen lds
    v_mfma_f32_16x16x32_bf16 v[8:11], v[88:91], a[236:239], v[8:11]
    s_nop 0
    ds_read_b64_tr_b16 a[120:121], v38 offset:8192
    ds_read_b64_tr_b16 a[122:123], v38 offset:12288
    v_mfma_f32_16x16x32_bf16 v[12:15], v[84:87], a[232:235], v[12:15]
    ds_read_b128 a[232:235], v36 offset:12288
    v_and_b32 v35, s60, v25
    v_mfma_f32_16x16x32_bf16 v[12:15], v[92:95], a[236:239], v[12:15]
    s_waitcnt lgkmcnt(11)
    ds_read_b128 a[236:239], v36 offset:13312
    v_lshlrev_b32 v32, 16, v29
    v_mfma_f32_16x16x32_bf16 v[8:11], v[96:99], a[208:211], v[8:11]
    buffer_load_dwordx4 v41, s[20:23], s46 offen offset:1024 lds
    v_mfma_f32_16x16x32_bf16 v[8:11], v[104:107], a[212:215], v[8:11]
    s_waitcnt vmcnt(13)
    v_cmp_ne_u32 vcc, s45, v47
    s_cbranch_vccnz L_slow15
L_back15:
    v_mfma_f32_16x16x32_bf16 v[12:15], v[100:103], a[208:211], v[12:15]
    s_mov_b32 m0, s67
    ds_read_b128 a[208:211], v36 offset:14336
    v_and_b32 v34, s60, v29
    v_mfma_f32_16x16x32_bf16 v[12:15], v[108:111], a[212:215], v[12:15]
    s_waitcnt lgkmcnt(9)
    ds_read_b128 a[212:215], v36 offset:15360
    v_fmac_f32 v33, v32, v2
    v_mfma_f32_16x16x32_bf16 v[8:11], v[112:115], a[216:219], v[8:11]
    buffer_load_dwordx4 v42, s[24:27], s35 offen offset:0 sc1 lds
    v_mfma_f32_16x16x32_bf16 v[8:11], v[120:123], a[220:223], v[8:11]
    s_addk_i32 s49, 4096
    ds_read_b64_tr_b16 a[124:125], v39 offset:8192
    ds_read_b64_tr_b16 a[126:127], v39 offset:12288
    v_mfma_f32_16x16x32_bf16 v[12:15], v[116:119], a[216:219], v[12:15]
    s_add_u32 s54, s35, s64
    ds_read_b128 a[216:219], v36 offset:16384
    v_fmac_f32 v35, v34, v3
    v_mfma_f32_16x16x32_bf16 v[12:15], v[124:127], a[220:223], v[12:15]
    s_waitcnt lgkmcnt(9)
    ds_read_b128 a[220:223], v36 offset:17408
    v_cvt_pk_bf16_f32 v29, v33, v35
    v_mfma_f32_16x16x32_bf16 v[8:11], v[128:131], a[224:227], v[8:11]
    buffer_load_dwordx4 v42, s[24:27], s35 offen offset:1024 sc1 lds
    v_mfma_f32_16x16x32_bf16 v[8:11], v[136:139], a[228:231], v[8:11]
    buffer_load_dword v47, v46, s[24:27], s49 offen sc1
    v_mfma_f32_16x16x32_bf16 v[12:15], v[132:135], a[224:227], v[12:15]
    ds_read_b128 a[224:227], v36 offset:18432
    v_lshlrev_b32 v33, 16, v26
    v_mfma_f32_16x16x32_bf16 v[12:15], v[140:143], a[228:231], v[12:15]
    s_waitcnt lgkmcnt(7)
    ds_read_b128 a[228:231], v36 offset:19456
    v_and_b32 v35, s60, v26
    v_mfma_f32_16x16x32_bf16 v[8:11], v[144:147], a[232:235], v[8:11]
    buffer_load_dwordx4 v42, s[24:27], s35 offen offset:2048 sc1 lds
    v_mfma_f32_16x16x32_bf16 v[8:11], v[152:155], a[236:239], v[8:11]
    s_nop 0
    ds_read_b64_tr_b16 a[128:129], v38 offset:16384
    ds_read_b64_tr_b16 a[130:131], v38 offset:20480
    v_mfma_f32_16x16x32_bf16 v[12:15], v[148:151], a[232:235], v[12:15]
    ds_read_b128 a[232:235], v36 offset:20480
    v_lshlrev_b32 v32, 16, v30
    v_mfma_f32_16x16x32_bf16 v[12:15], v[156:159], a[236:239], v[12:15]
    s_waitcnt lgkmcnt(9)
    ds_read_b128 a[236:239], v36 offset:21504
    v_and_b32 v34, s60, v30
    v_mfma_f32_16x16x32_bf16 v[8:11], v[160:163], a[208:211], v[8:11]
    buffer_load_dwordx4 v42, s[24:27], s35 offen offset:3072 sc1 lds
    v_mfma_f32_16x16x32_bf16 v[8:11], v[168:171], a[212:215], v[8:11]
    s_addk_i32 m0, 4096
    ds_read_b64_tr_b16 a[132:133], v39 offset:16384
    ds_read_b64_tr_b16 a[134:135], v39 offset:20480
    v_mfma_f32_16x16x32_bf16 v[12:15], v[164:167], a[208:211], v[12:15]
    s_add_u32 s0, s0, s63
    ds_read_b128 a[208:211], v36 offset:22528
    v_fmac_f32 v33, v32, v4
    v_mfma_f32_16x16x32_bf16 v[12:15], v[172:175], a[212:215], v[12:15]
    s_waitcnt lgkmcnt(9)
    ds_read_b128 a[212:215], v36 offset:23552
    v_fmac_f32 v35, v34, v5
    v_mfma_f32_16x16x32_bf16 v[8:11], v[176:179], a[216:219], v[8:11]
    buffer_load_dwordx4 v42, s[24:27], s54 offen offset:0 sc1 lds
    v_mfma_f32_16x16x32_bf16 v[8:11], v[184:187], a[220:223], v[8:11]
    s_add_u32 s47, s46, s61
    v_cvt_pk_bf16_f32 v30, v33, v35
    v_lshlrev_b32 v33, 16, v27
    v_mfma_f32_16x16x32_bf16 v[12:15], v[180:183], a[216:219], v[12:15]
    ds_read_b128 a[216:219], v36 offset:24576
    v_and_b32 v35, s60, v27
    v_mfma_f32_16x16x32_bf16 v[12:15], v[188:191], a[220:223], v[12:15]
    s_waitcnt lgkmcnt(9)
    ds_read_b128 a[220:223], v36 offset:25600
    v_add_u32 v36, 26624, v36
    v_mfma_f32_16x16x32_bf16 v[8:11], v[192:195], a[224:227], v[8:11]
    s_waitcnt vmcnt(13)
    buffer_store_dword v37, v45, s[24:27], s14 offen sc1
    v_mfma_f32_16x16x32_bf16 v[8:11], v[200:203], a[228:231], v[8:11]
    buffer_load_dwordx4 v42, s[24:27], s54 offen offset:1024 sc1 lds
    v_mfma_f32_16x16x32_bf16 v[12:15], v[196:199], a[224:227], v[12:15]
    s_mov_b32 m0, s32
    ds_read_b128 v[24:27], v44 offset:26624
    v_lshlrev_b32 v32, 16, v31
    v_mfma_f32_16x16x32_bf16 v[12:15], v[204:207], a[228:231], v[12:15]
    s_waitcnt lgkmcnt(7)
    v_and_b32 v34, s60, v31
    v_fmac_f32 v33, v32, v6
    v_mfma_f32_16x16x32_bf16 v[8:11], v[208:211], a[232:235], v[8:11]
    v_fmac_f32 v35, v34, v7
    v_cvt_pk_bf16_f32 v31, v33, v35
    v_mfma_f32_16x16x32_bf16 v[8:11], v[216:219], a[236:239], v[8:11]
    buffer_load_dwordx4 v42, s[24:27], s0 offen offset:0 sc1 lds
    s_mov_b32 m0, s65
    buffer_store_dwordx4 v[28:31], v44, s[24:27], s1 offen sc1
    s_waitcnt vmcnt(10) lgkmcnt(0)
    s_barrier
    v_mfma_f32_16x16x32_bf16 v[12:15], v[212:215], a[232:235], v[12:15]
    buffer_load_dwordx4 v40, s[20:23], s47 offen lds
    v_mfma_f32_16x16x32_bf16 v[12:15], v[220:223], a[236:239], v[12:15]
    s_add_u32 s46, s47, s61
    ds_read_b128 a[224:227], v36 offset:0
    v_accvgpr_read_b32 v28, a244
    v_mfma_f32_16x16x32_bf16 v[8:11], v[224:227], a[208:211], v[8:11]
    s_addk_i32 s14, 4096
    ds_read_b128 a[228:231], v36 offset:1024
    v_accvgpr_read_b32 v29, a245
    v_mfma_f32_16x16x32_bf16 v[8:11], v[232:235], a[212:215], v[8:11]
    s_add_u32 s1, s1, s63
    ds_read_b128 a[232:235], v36 offset:2048
    v_accvgpr_read_b32 v30, a246
    v_mfma_f32_16x16x32_bf16 v[12:15], v[228:231], a[208:211], v[12:15]
    ds_read_b128 a[236:239], v36 offset:3072
    v_accvgpr_read_b32 v31, a247
    v_mfma_f32_16x16x32_bf16 v[12:15], v[236:239], a[212:215], v[12:15]
    ds_read_b128 a[208:211], v36 offset:4096
    v_lshlrev_b32 v33, 16, v24
    v_mfma_f32_16x16x32_bf16 v[8:11], v[240:243], a[216:219], v[8:11]
    ds_read_b128 a[212:215], v36 offset:5120
    v_and_b32 v35, s60, v24
    v_mfma_f32_16x16x32_bf16 v[8:11], v[248:251], a[220:223], v[8:11]
    buffer_load_dwordx4 v41, s[20:23], s47 offen offset:1024 lds
    v_mfma_f32_16x16x32_bf16 v[12:15], v[244:247], a[216:219], v[12:15]
    s_addk_i32 m0, 8192
    ds_read_b128 a[216:219], v36 offset:6144
    v_lshlrev_b32 v32, 16, v28
    v_mfma_f32_16x16x32_bf16 v[12:15], v[252:255], a[220:223], v[12:15]
    s_waitcnt lgkmcnt(5)
    ds_read_b128 a[220:223], v36 offset:7168
    v_and_b32 v34, s60, v28
    v_mfma_f32_16x16x32_bf16 v[0:3], v[48:51], a[224:227], v[16:19]
    buffer_load_dwordx4 v40, s[20:23], s46 offen lds
    v_mfma_f32_16x16x32_bf16 v[0:3], v[56:59], a[228:231], v[0:3]
    s_add_u32 s47, s46, s61
    ds_read_b64_tr_b16 a[136:137], v38 offset:32768
    ds_read_b64_tr_b16 a[138:139], v38 offset:36864
    v_mfma_f32_16x16x32_bf16 v[4:7], v[52:55], a[224:227], v[20:23]
    s_add_u32 s35, s35, s63
    ds_read_b128 a[224:227], v36 offset:8192
    v_fmac_f32 v33, v32, v8
    v_mfma_f32_16x16x32_bf16 v[4:7], v[60:63], a[228:231], v[4:7]
    s_waitcnt lgkmcnt(7)
    ds_read_b128 a[228:231], v36 offset:9216
    v_fmac_f32 v35, v34, v9
    v_mfma_f32_16x16x32_bf16 v[0:3], v[64:67], a[232:235], v[0:3]
    buffer_load_dwordx4 v41, s[20:23], s46 offen offset:1024 lds
    v_mfma_f32_16x16x32_bf16 v[0:3], v[72:75], a[236:239], v[0:3]
    s_addk_i32 m0, 8192
    ds_read_b64_tr_b16 a[140:141], v39 offset:32768
    ds_read_b64_tr_b16 a[142:143], v39 offset:36864
    v_mfma_f32_16x16x32_bf16 v[4:7], v[68:71], a[232:235], v[4:7]
    ds_read_b128 a[232:235], v36 offset:10240
    v_cvt_pk_bf16_f32 v28, v33, v35
    v_mfma_f32_16x16x32_bf16 v[4:7], v[76:79], a[236:239], v[4:7]
    s_waitcnt lgkmcnt(9)
    ds_read_b128 a[236:239], v36 offset:11264
    v_lshlrev_b32 v33, 16, v25
    v_mfma_f32_16x16x32_bf16 v[0:3], v[80:83], a[208:211], v[0:3]
    buffer_load_dwordx4 v40, s[20:23], s47 offen lds
    v_mfma_f32_16x16x32_bf16 v[0:3], v[88:91], a[212:215], v[0:3]
L_page5:
    s_cbranch_execz L_walk_back
    s_nop 0
    ds_read_b64_tr_b16 a[144:145], v38 offset:40960
    ds_read_b64_tr_b16 a[146:147], v38 offset:45056
    v_mfma_f32_16x16x32_bf16 v[4:7], v[84:87], a[208:211], v[4:7]
    ds_read_b128 a[208:211], v36 offset:12288
    v_and_b32 v35, s60, v25
    v_mfma_f32_16x16x32_bf16 v[4:7], v[92:95], a[212:215], v[4:7]
    s_waitcnt lgkmcnt(11)
    ds_read_b128 a[212:215], v36 offset:13312
    v_lshlrev_b32 v32, 16, v29
    v_mfma_f32_16x16x32_bf16 v[0:3], v[96:99], a[216:219], v[0:3]
    buffer_load_dwordx4 v41, s[20:23], s47 offen offset:1024 lds
    v_mfma_f32_16x16x32_bf16 v[0:3], v[104:107], a[220:223], v[0:3]
    s_waitcnt vmcnt(13)
    v_cmp_ne_u32 vcc, s45, v47
    s_cbranch_vccnz L_slow16
L_back16:
    v_mfma_f32_16x16x32_bf16 v[4:7], v[100:103], a[216:219], v[4:7]
    s_mov_b32 m0, s68
    ds_read_b128 a[216:219], v36 offset:14336
    v_and_b32 v34, s60, v29
    v_mfma_f32_16x16x32_bf16 v[4:7], v[108:111], a[220:223], v[4:7]
    s_waitcnt lgkmcnt(9)
    ds_read_b128 a[220:223], v36 offset:15360
    v_fmac_f32 v33, v32, v10
    v_mfma_f32_16x16x32_bf16 v[0:3], v[112:115], a[224:227], v[0:3]
    buffer_load_dwordx4 v42, s[24:27], s35 offen offset:0 sc1 lds
    v_mfma_f32_16x16x32_bf16 v[0:3], v[120:123], a[228:231], v[0:3]
    s_addk_i32 s49, 4096
    ds_read_b64_tr_b16 a[148:149], v39 offset:40960
    ds_read_b64_tr_b16 a[150:151], v39 offset:45056
    v_mfma_f32_16x16x32_bf16 v[4:7], v[116:119], a[224:227], v[4:7]
    s_add_u32 s54, s35, s64
    ds_read_b128 a[224:227], v36 offset:16384
    v_fmac_f32 v35, v34, v11
    v_mfma_f32_16x16x32_bf16 v[4:7], v[124:127], a[228:231], v[4:7]
    s_waitcnt lgkmcnt(9)
    ds_read_b128 a[228:231], v36 offset:17408
    v_cvt_pk_bf16_f32 v29, v33, v35
    v_mfma_f32_16x16x32_bf16 v[0:3], v[128:131], a[232:235], v[0:3]
    buffer_load_dwordx4 v42, s[24:27], s35 offen offset:1024 sc1 lds
    v_mfma_f32_16x16x32_bf16 v[0:3], v[136:139], a[236:239], v[0:3]
    buffer_load_dword v47, v46, s[24:27], s49 offen sc1
    v_mfma_f32_16x16x32_bf16 v[4:7], v[132:135], a[232:235], v[4:7]
    ds_read_b128 a[232:235], v36 offset:18432
    v_lshlrev_b32 v33, 16, v26
    v_mfma_f32_16x16x32_bf16 v[4:7], v[140:143], a[236:239], v[4:7]
    s_waitcnt lgkmcnt(7)
    ds_read_b128 a[236:239], v36 offset:19456
    v_and_b32 v35, s60, v26
    v_mfma_f32_16x16x32_bf16 v[0:3], v[144:147], a[208:211], v[0:3]
    buffer_load_dwordx4 v42, s[24:27], s35 offen offset:2048 sc1 lds
    v_mfma_f32_16x16x32_bf16 v[0:3], v[152:155], a[212:215], v[0:3]
    s_nop 0
    ds_read_b64_tr_b16 a[152:153], v38 offset:49152
    ds_read_b64_tr_b16 a[154:155], v38 offset:53248
    v_mfma_f32_16x16x32_bf16 v[4:7], v[148:151], a[208:211], v[4:7]
    ds_read_b128 a[208:211], v36 offset:20480
    v_lshlrev_b32 v32, 16, v30
    v_mfma_f32_16x16x32_bf16 v[4:7], v[156:159], a[212:215], v[4:7]
    s_waitcnt lgkmcnt(9)
    ds_read_b128 a[212:215], v36 offset:21504
    v_and_b32 v34, s60, v30
    v_mfma_f32_16x16x32_bf16 v[0:3], v[160:163], a[216:219], v[0:3]
    buffer_load_dwordx4 v42, s[24:27], s35 offen offset:3072 sc1 lds
    v_mfma_f32_16x16x32_bf16 v[0:3], v[168:171], a[220:223], v[0:3]
    s_addk_i32 m0, 4096
    ds_read_b64_tr_b16 a[156:157], v39 offset:49152
    ds_read_b64_tr_b16 a[158:159], v39 offset:53248
    v_mfma_f32_16x16x32_bf16 v[4:7], v[164:167], a[216:219], v[4:7]
    s_add_u32 s0, s0, s63
    ds_read_b128 a[216:219], v36 offset:22528
    v_fmac_f32 v33, v32, v12
    v_mfma_f32_16x16x32_bf16 v[4:7], v[172:175], a[220:223], v[4:7]
    s_waitcnt lgkmcnt(9)
    ds_read_b128 a[220:223], v36 offset:23552
    v_fmac_f32 v35, v34, v13
    v_mfma_f32_16x16x32_bf16 v[0:3], v[176:179], a[224:227], v[0:3]
    buffer_load_dwordx4 v42, s[24:27], s54 offen offset:0 sc1 lds
    v_mfma_f32_16x16x32_bf16 v[0:3], v[184:187], a[228:231], v[0:3]
    s_add_u32 s46, s47, s61
    v_cvt_pk_bf16_f32 v30, v33, v35
    v_lshlrev_b32 v33, 16, v27
    v_mfma_f32_16x16x32_bf16 v[4:7], v[180:183], a[224:227], v[4:7]
    ds_read_b128 a[224:227], v36 offset:24576
    v_and_b32 v35, s60, v27
    v_mfma_f32_16x16x32_bf16 v[4:7], v[188:191], a[228:231], v[4:7]
    s_waitcnt lgkmcnt(9)
    ds_read_b128 a[228:231], v36 offset:25600
    v_subrev_u32 v36, 53248, v36
    v_mfma_f32_16x16x32_bf16 v[0:3], v[192:195], a[232:235], v[0:3]
    s_waitcnt vmcnt(12)
    buffer_store_dword v37, v45, s[24:27], s14 offen sc1
    v_mfma_f32_16x16x32_bf16 v[0:3], v[200:203], a[236:239], v[0:3]
    buffer_load_dwordx4 v42, s[24:27], s54 offen offset:1024 sc1 lds
    v_mfma_f32_16x16x32_bf16 v[4:7], v[196:199], a[232:235], v[4:7]
    s_mov_b32 m0, s33
    ds_read_b128 v[24:27], v44 offset:53248
    v_lshlrev_b32 v32, 16, v31
    v_mfma_f32_16x16x32_bf16 v[4:7], v[204:207], a[236:239], v[4:7]
    s_waitcnt lgkmcnt(7)
    v_and_b32 v34, s60, v31
    v_fmac_f32 v33, v32, v14
    v_mfma_f32_16x16x32_bf16 v[0:3], v[208:211], a[208:211], v[0:3]
    v_fmac_f32 v35, v34, v15
    v_cvt_pk_bf16_f32 v31, v33, v35
    v_mfma_f32_16x16x32_bf16 v[0:3], v[216:219], a[212:215], v[0:3]
    buffer_load_dwordx4 v42, s[24:27], s0 offen offset:0 sc1 lds
    s_mov_b32 m0, s66
    buffer_store_dwordx4 v[28:31], v44, s[24:27], s1 offen sc1
    s_waitcnt vmcnt(10) lgkmcnt(0)
    s_barrier
    v_mfma_f32_16x16x32_bf16 v[4:7], v[212:215], a[208:211], v[4:7]
    buffer_load_dwordx4 v40, s[20:23], s46 offen lds
    v_mfma_f32_16x16x32_bf16 v[4:7], v[220:223], a[212:215], v[4:7]
    s_add_u32 s47, s46, s61
    ds_read_b128 a[232:235], v36 offset:0
    v_accvgpr_read_b32 v28, a248
    v_mfma_f32_16x16x32_bf16 v[0:3], v[224:227], a[216:219], v[0:3]
    s_addk_i32 s14, 4096
    ds_read_b128 a[236:239], v36 offset:1024
    v_accvgpr_read_b32 v29, a249
    v_mfma_f32_16x16x32_bf16 v[0:3], v[232:235], a[220:223], v[0:3]
    s_add_u32 s1, s1, s63
    ds_read_b128 a[208:211], v36 offset:2048
    v_accvgpr_read_b32 v30, a250
    v_mfma_f32_16x16x32_bf16 v[4:7], v[228:231], a[216:219], v[4:7]
    ds_read_b128 a[212:215], v36 offset:3072
    v_accvgpr_read_b32 v31, a251
    v_mfma_f32_16x16x32_bf16 v[4:7], v[236:239], a[220:223], v[4:7]
    ds_read_b128 a[216:219], v36 offset:4096
    v_lshlrev_b32 v33, 16, v24
    v_mfma_f32_16x16x32_bf16 v[0:3], v[240:243], a[224:227], v[0:3]
    ds_read_b128 a[220:223], v36 offset:5120
    v_and_b32 v35, s60, v24
    v_mfma_f32_16x16x32_bf16 v[0:3], v[248:251], a[228:231], v[0:3]
    buffer_load_dwordx4 v41, s[20:23], s46 offen offset:1024 lds
    v_mfma_f32_16x16x32_bf16 v[4:7], v[244:247], a[224:227], v[4:7]
    s_addk_i32 m0, 8192
    ds_read_b128 a[224:227], v36 offset:6144
    v_lshlrev_b32 v32, 16, v28
    v_mfma_f32_16x16x32_bf16 v[4:7], v[252:255], a[228:231], v[4:7]
    s_waitcnt lgkmcnt(5)
    ds_read_b128 a[228:231], v36 offset:7168
    v_and_b32 v34, s60, v28
    v_mfma_f32_16x16x32_bf16 v[8:11], v[48:51], a[232:235], v[16:19]
    buffer_load_dwordx4 v40, s[20:23], s47 offen lds
    v_mfma_f32_16x16x32_bf16 v[8:11], v[56:59], a[236:239], v[8:11]
    s_add_u32 s46, s47, s61
    ds_read_b64_tr_b16 a[160:161], v38 offset:0
    ds_read_b64_tr_b16 a[162:163], v38 offset:4096
    v_mfma_f32_16x16x32_bf16 v[12:15], v[52:55], a[232:235], v[20:23]
    s_add_u32 s35, s35, s63
    ds_read_b128 a[232:235], v36 offset:8192
    v_fmac_f32 v33, v32, v0
    v_mfma_f32_16x16x32_bf16 v[12:15], v[60:63], a[236:239], v[12:15]
    s_waitcnt lgkmcnt(7)
    ds_read_b128 a[236:239], v36 offset:9216
    v_fmac_f32 v35, v34, v1
    v_mfma_f32_16x16x32_bf16 v[8:11], v[64:67], a[208:211], v[8:11]
    buffer_load_dwordx4 v41, s[20:23], s47 offen offset:1024 lds
    v_mfma_f32_16x16x32_bf16 v[8:11], v[72:75], a[212:215], v[8:11]
    s_addk_i32 m0, 8192
    ds_read_b64_tr_b16 a[164:165], v39 offset:0
    ds_read_b64_tr_b16 a[166:167], v39 offset:4096
    v_mfma_f32_16x16x32_bf16 v[12:15], v[68:71], a[208:211], v[12:15]
    ds_read_b128 a[208:211], v36 offset:10240
    v_cvt_pk_bf16_f32 v28, v33, v35
    v_mfma_f32_16x16x32_bf16 v[12:15], v[76:79], a[212:215], v[12:15]
    s_waitcnt lgkmcnt(9)
    ds_read_b128 a[212:215], v36 offset:11264
    v_lshlrev_b32 v33, 16, v25
    v_mfma_f32_16x16x32_bf16 v[8:11], v[80:83], a[216:219], v[8:11]
    buffer_load_dwordx4 v40, s[20:23], s46 offen lds
    v_mfma_f32_16x16x32_bf16 v[8:11], v[88:91], a[220:223], v[8:11]
    s_nop 0
    ds_read_b64_tr_b16 a[168:169], v38 offset:8192
    ds_read_b64_tr_b16 a[170:171], v38 offset:12288
    v_mfma_f32_16x16x32_bf16 v[12:15], v[84:87], a[216:219], v[12:15]
    ds_read_b128 a[216:219], v36 offset:12288
    v_and_b32 v35, s60, v25
    v_mfma_f32_16x16x32_bf16 v[12:15], v[92:95], a[220:223], v[12:15]
    s_waitcnt lgkmcnt(11)
    ds_read_b128 a[220:223], v36 offset:13312
    v_lshlrev_b32 v32, 16, v29
    v_mfma_f32_16x16x32_bf16 v[8:11], v[96:99], a[224:227], v[8:11]
    buffer_load_dwordx4 v41, s[20:23], s46 offen offset:1024 lds
    v_mfma_f32_16x16x32_bf16 v[8:11], v[104:107], a[228:231], v[8:11]
    s_waitcnt vmcnt(13)
    v_cmp_ne_u32 vcc, s45, v47
    s_cbranch_vccnz L_slow17
L_back17:
    v_mfma_f32_16x16x32_bf16 v[12:15], v[100:103], a[224:227], v[12:15]
    s_mov_b32 m0, s69
    ds_read_b128 a[224:227], v36 offset:14336
    v_and_b32 v34, s60, v29
    v_mfma_f32_16x16x32_bf16 v[12:15], v[108:111], a[228:231], v[12:15]
    s_waitcnt lgkmcnt(9)
    ds_read_b128 a[228:231], v36 offset:15360
    v_fmac_f32 v33, v32, v2
    v_mfma_f32_16x16x32_bf16 v[8:11], v[112:115], a[232:235], v[8:11]
    buffer_load_dwordx4 v42, s[24:27], s35 offen offset:0 sc1 lds
    v_mfma_f32_16x16x32_bf16 v[8:11], v[120:123], a[236:239], v[8:11]
    s_addk_i32 s49, 4096
    ds_read_b64_tr_b16 a[172:173], v39 offset:8192
    ds_read_b64_tr_b16 a[174:175], v39 offset:12288
    v_mfma_f32_16x16x32_bf16 v[12:15], v[116:119], a[232:235], v[12:15]
    s_add_u32 s54, s35, s64
    ds_read_b128 a[232:235], v36 offset:16384
    v_fmac_f32 v35, v34, v3
    v_mfma_f32_16x16x32_bf16 v[12:15], v[124:127], a[236:239], v[12:15]
    s_waitcnt lgkmcnt(9)
    ds_read_b128 a[236:239], v36 offset:17408
    v_cvt_pk_bf16_f32 v29, v33, v35
    v_mfma_f32_16x16x32_bf16 v[8:11], v[128:131], a[208:211], v[8:11]
    buffer_load_dwordx4 v42, s[24:27], s35 offen offset:1024 sc1 lds
    v_mfma_f32_16x16x32_bf16 v[8:11], v[136:139], a[212:215], v[8:11]
    buffer_load_dword v47, v46, s[24:27], s49 offen sc1
    v_mfma_f32_16x16x32_bf16 v[12:15], v[132:135], a[208:211], v[12:15]
    ds_read_b128 a[208:211], v36 offset:18432
    v_lshlrev_b32 v33, 16, v26
    v_mfma_f32_16x16x32_bf16 v[12:15], v[140:143], a[212:215], v[12:15]
    s_waitcnt lgkmcnt(7)
    ds_read_b128 a[212:215], v36 offset:19456
    v_and_b32 v35, s60, v26
    v_mfma_f32_16x16x32_bf16 v[8:11], v[144:147], a[216:219], v[8:11]
    buffer_load_dwordx4 v42, s[24:27], s35 offen offset:2048 sc1 lds
    v_mfma_f32_16x16x32_bf16 v[8:11], v[152:155], a[220:223], v[8:11]
    s_nop 0
    ds_read_b64_tr_b16 a[176:177], v38 offset:16384
    ds_read_b64_tr_b16 a[178:179], v38 offset:20480
    v_mfma_f32_16x16x32_bf16 v[12:15], v[148:151], a[216:219], v[12:15]
    ds_read_b128 a[216:219], v36 offset:20480
    v_lshlrev_b32 v32, 16, v30
    v_mfma_f32_16x16x32_bf16 v[12:15], v[156:159], a[220:223], v[12:15]
    s_waitcnt lgkmcnt(9)
    ds_read_b128 a[220:223], v36 offset:21504
    v_and_b32 v34, s60, v30
    v_mfma_f32_16x16x32_bf16 v[8:11], v[160:163], a[224:227], v[8:11]
    buffer_load_dwordx4 v42, s[24:27], s35 offen offset:3072 sc1 lds
    v_mfma_f32_16x16x32_bf16 v[8:11], v[168:171], a[228:231], v[8:11]
    s_addk_i32 m0, 4096
    ds_read_b64_tr_b16 a[180:181], v39 offset:16384
    ds_read_b64_tr_b16 a[182:183], v39 offset:20480
    v_mfma_f32_16x16x32_bf16 v[12:15], v[164:167], a[224:227], v[12:15]
    s_add_u32 s0, s0, s63
    ds_read_b128 a[224:227], v36 offset:22528
    v_fmac_f32 v33, v32, v4
    v_mfma_f32_16x16x32_bf16 v[12:15], v[172:175], a[228:231], v[12:15]
    s_waitcnt lgkmcnt(9)
    ds_read_b128 a[228:231], v36 offset:23552
    v_fmac_f32 v35, v34, v5
    v_mfma_f32_16x16x32_bf16 v[8:11], v[176:179], a[232:235], v[8:11]
    buffer_load_dwordx4 v42, s[24:27], s54 offen offset:0 sc1 lds
    v_mfma_f32_16x16x32_bf16 v[8:11], v[184:187], a[236:239], v[8:11]
    v_cvt_pk_bf16_f32 v30, v33, v35
    v_lshlrev_b32 v33, 16, v27
    v_mfma_f32_16x16x32_bf16 v[12:15], v[180:183], a[232:235], v[12:15]
    ds_read_b128 a[232:235], v36 offset:24576
    v_and_b32 v35, s60, v27
    v_mfma_f32_16x16x32_bf16 v[12:15], v[188:191], a[236:239], v[12:15]
    s_waitcnt lgkmcnt(9)
    ds_read_b128 a[236:239], v36 offset:25600
    v_add_u32 v36, 26624, v36
    v_mfma_f32_16x16x32_bf16 v[8:11], v[192:195], a[208:211], v[8:11]
    s_waitcnt vmcnt(12)
    buffer_store_dword v37, v45, s[24:27], s14 offen sc1
    v_mfma_f32_16x16x32_bf16 v[8:11], v[200:203], a[212:215], v[8:11]
    buffer_load_dwordx4 v42, s[24:27], s54 offen offset:1024 sc1 lds
    v_mfma_f32_16x16x32_bf16 v[12:15], v[196:199], a[208:211], v[12:15]
    s_mov_b32 m0, s34
    ds_read_b128 v[24:27], v44 offset:0
    v_lshlrev_b32 v32, 16, v31
    v_mfma_f32_16x16x32_bf16 v[12:15], v[204:207], a[212:215], v[12:15]
    s_waitcnt lgkmcnt(7)
    v_and_b32 v34, s60, v31
    v_fmac_f32 v33, v32, v6
    v_mfma_f32_16x16x32_bf16 v[8:11], v[208:211], a[216:219], v[8:11]
    v_fmac_f32 v35, v34, v7
    v_cvt_pk_bf16_f32 v31, v33, v35
    v_mfma_f32_16x16x32_bf16 v[8:11], v[216:219], a[220:223], v[8:11]
    buffer_load_dwordx4 v42, s[24:27], s0 offen offset:0 sc1 lds
    buffer_store_dwordx4 v[28:31], v44, s[24:27], s1 offen sc1
    v_mbcnt_lo_u32_b32 v35, -1, 0
    v_mbcnt_hi_u32_b32 v35, -1, v35
    s_lshl_b32 s56, s3, 8
    v_and_b32 v35, 48, v35
    s_add_u32 s56, s56, 161920
    v_add_u32 v35, s56, v35
    ds_read_b128 v[16:19], v35 offset:0
    ds_read_b128 v[20:23], v35 offset:64
    s_waitcnt vmcnt(10) lgkmcnt(0)
    s_barrier
    v_mfma_f32_16x16x32_bf16 v[12:15], v[212:215], a[216:219], v[12:15]
    s_addk_i32 s14, 4096
    ds_read_b128 a[208:211], v36 offset:0
    v_accvgpr_read_b32 v28, a252
    v_mfma_f32_16x16x32_bf16 v[12:15], v[220:223], a[220:223], v[12:15]
    ds_read_b128 a[212:215], v36 offset:1024
    v_accvgpr_read_b32 v29, a253
    v_mfma_f32_16x16x32_bf16 v[8:11], v[224:227], a[224:227], v[8:11]
    s_add_u32 s1, s1, s63
    ds_read_b128 a[216:219], v36 offset:2048
    v_accvgpr_read_b32 v30, a254
    v_mfma_f32_16x16x32_bf16 v[8:11], v[232:235], a[228:231], v[8:11]
    ds_read_b128 a[220:223], v36 offset:3072
    v_accvgpr_read_b32 v31, a255
    v_mfma_f32_16x16x32_bf16 v[12:15], v[228:231], a[224:227], v[12:15]
    ds_read_b128 a[224:227], v36 offset:4096
    v_lshlrev_b32 v33, 16, v24
    v_mfma_f32_16x16x32_bf16 v[12:15], v[236:239], a[228:231], v[12:15]
    ds_read_b128 a[228:231], v36 offset:5120
    v_and_b32 v35, s60, v24
    v_mfma_f32_16x16x32_bf16 v[8:11], v[240:243], a[232:235], v[8:11]
    s_nop 0
    ds_read_b64_tr_b16 a[184:185], v38 offset:32768
    ds_read_b64_tr_b16 a[186:187], v38 offset:36864
    v_mfma_f32_16x16x32_bf16 v[8:11], v[248:251], a[236:239], v[8:11]
    s_nop 0
    ds_read_b64_tr_b16 a[188:189], v39 offset:32768
    ds_read_b64_tr_b16 a[190:191], v39 offset:36864
    v_mfma_f32_16x16x32_bf16 v[12:15], v[244:247], a[232:235], v[12:15]
    ds_read_b128 a[232:235], v36 offset:6144
    v_lshlrev_b32 v32, 16, v28
    v_mfma_f32_16x16x32_bf16 v[12:15], v[252:255], a[236:239], v[12:15]
    s_waitcnt lgkmcnt(9)
    ds_read_b128 a[236:239], v36 offset:7168
    v_and_b32 v34, s60, v28
    v_mfma_f32_16x16x32_bf16 v[0:3], a[0:3], a[208:211], v[16:19]
    s_nop 0
    ds_read_b64_tr_b16 a[192:193], v38 offset:40960
    ds_read_b64_tr_b16 a[194:195], v38 offset:45056
    v_mfma_f32_16x16x32_bf16 v[0:3], a[8:11], a[212:215], v[0:3]
    s_nop 0
    ds_read_b64_tr_b16 a[196:197], v39 offset:40960
    ds_read_b64_tr_b16 a[198:199], v39 offset:45056
    v_mfma_f32_16x16x32_bf16 v[4:7], a[4:7], a[208:211], v[20:23]
    s_add_u32 s35, s35, s63
    ds_read_b128 a[208:211], v36 offset:8192
    v_fmac_f32 v33, v32, v8
    v_mfma_f32_16x16x32_bf16 v[4:7], a[12:15], a[212:215], v[4:7]
    s_waitcnt lgkmcnt(13)
    ds_read_b128 a[212:215], v36 offset:9216
    v_fmac_f32 v35, v34, v9
    v_mfma_f32_16x16x32_bf16 v[0:3], a[16:19], a[216:219], v[0:3]
    s_nop 0
    ds_read_b64_tr_b16 a[200:201], v38 offset:49152
    ds_read_b64_tr_b16 a[202:203], v38 offset:53248
    v_mfma_f32_16x16x32_bf16 v[0:3], a[24:27], a[220:223], v[0:3]
    s_nop 0
    ds_read_b64_tr_b16 a[204:205], v39 offset:49152
    ds_read_b64_tr_b16 a[206:207], v39 offset:53248
    v_mfma_f32_16x16x32_bf16 v[4:7], a[20:23], a[216:219], v[4:7]
    ds_read_b128 a[216:219], v36 offset:10240
    v_cvt_pk_bf16_f32 v28, v33, v35
    v_mfma_f32_16x16x32_bf16 v[4:7], a[28:31], a[220:223], v[4:7]
    s_waitcnt lgkmcnt(15)
    ds_read_b128 a[220:223], v36 offset:11264
    v_lshlrev_b32 v33, 16, v25
    v_mfma_f32_16x16x32_bf16 v[0:3], a[32:35], a[224:227], v[0:3]
    s_mov_b32 m0, s67
    v_and_b32 v35, s60, v25
    v_lshlrev_b32 v32, 16, v29
    v_mfma_f32_16x16x32_bf16 v[0:3], a[40:43], a[228:231], v[0:3]
    v_and_b32 v34, s60, v29
    v_fmac_f32 v33, v32, v10
    v_mfma_f32_16x16x32_bf16 v[4:7], a[36:39], a[224:227], v[4:7]
    ds_read_b128 a[224:227], v36 offset:12288
    v_fmac_f32 v35, v34, v11
    v_mfma_f32_16x16x32_bf16 v[4:7], a[44:47], a[228:231], v[4:7]
    s_waitcnt lgkmcnt(13)
    ds_read_b128 a[228:231], v36 offset:13312
    v_cvt_pk_bf16_f32 v29, v33, v35
    v_mfma_f32_16x16x32_bf16 v[0:3], a[48:51], a[232:235], v[0:3]
    v_lshlrev_b32 v33, 16, v26
    v_and_b32 v35, s60, v26
    v_mfma_f32_16x16x32_bf16 v[0:3], a[56:59], a[236:239], v[0:3]
    s_waitcnt vmcnt(7)
    v_cmp_ne_u32 vcc, s45, v47
    s_cbranch_vccnz L_slow18
L_back18:
    v_mfma_f32_16x16x32_bf16 v[4:7], a[52:55], a[232:235], v[4:7]
    s_addk_i32 s49, 4096
    ds_read_b128 a[232:235], v36 offset:14336
    v_lshlrev_b32 v32, 16, v30
    v_mfma_f32_16x16x32_bf16 v[4:7], a[60:63], a[236:239], v[4:7]
    s_waitcnt lgkmcnt(9)
    ds_read_b128 a[236:239], v36 offset:15360
    v_and_b32 v34, s60, v30
    v_mfma_f32_16x16x32_bf16 v[0:3], a[64:67], a[208:211], v[0:3]
    buffer_load_dwordx4 v42, s[24:27], s35 offen offset:0 sc1 lds
    v_mfma_f32_16x16x32_bf16 v[0:3], a[72:75], a[212:215], v[0:3]
    v_fmac_f32 v33, v32, v12
    v_fmac_f32 v35, v34, v13
    v_mfma_f32_16x16x32_bf16 v[4:7], a[68:71], a[208:211], v[4:7]
    ds_read_b128 a[208:211], v36 offset:16384
    v_cvt_pk_bf16_f32 v30, v33, v35
    v_mfma_f32_16x16x32_bf16 v[4:7], a[76:79], a[212:215], v[4:7]
    s_waitcnt lgkmcnt(5)
    ds_read_b128 a[212:215], v36 offset:17408
    v_lshlrev_b32 v33, 16, v27
    v_mfma_f32_16x16x32_bf16 v[0:3], a[80:83], a[216:219], v[0:3]
    buffer_load_dwordx4 v42, s[24:27], s35 offen offset:1024 sc1 lds
    v_mfma_f32_16x16x32_bf16 v[0:3], a[88:91], a[220:223], v[0:3]
    buffer_load_dword v47, v46, s[24:27], s49 offen sc1
    v_mfma_f32_16x16x32_bf16 v[4:7], a[84:87], a[216:219], v[4:7]
    s_add_u32 s54, s35, s64
    ds_read_b128 a[216:219], v36 offset:18432
    v_and_b32 v35, s60, v27
    v_mfma_f32_16x16x32_bf16 v[4:7], a[92:95], a[220:223], v[4:7]
    s_waitcnt lgkmcnt(5)
    ds_read_b128 a[220:223], v36 offset:19456
    ds_read_b128 v[24:27], v44 offset:26624
    v_mfma_f32_16x16x32_bf16 v[0:3], a[96:99], a[224:227], v[0:3]
    buffer_load_dwordx4 v42, s[24:27], s35 offen offset:2048 sc1 lds
    v_mfma_f32_16x16x32_bf16 v[0:3], a[104:107], a[228:231], v[0:3]
    v_lshlrev_b32 v32, 16, v31
    v_and_b32 v34, s60, v31
    v_mfma_f32_16x16x32_bf16 v[4:7], a[100:103], a[224:227], v[4:7]
    ds_read_b128 a[224:227], v36 offset:20480
    v_fmac_f32 v33, v32, v14
    v_mfma_f32_16x16x32_bf16 v[4:7], a[108:111], a[228:231], v[4:7]
    s_waitcnt lgkmcnt(6)
    ds_read_b128 a[228:231], v36 offset:21504
    v_fmac_f32 v35, v34, v15
    v_mfma_f32_16x16x32_bf16 v[0:3], a[112:115], a[232:235], v[0:3]
    buffer_load_dwordx4 v42, s[24:27], s35 offen offset:3072 sc1 lds
    v_mfma_f32_16x16x32_bf16 v[0:3], a[120:123], a[236:239], v[0:3]
    s_addk_i32 m0, 4096
    v_cvt_pk_bf16_f32 v31, v33, v35
    v_mbcnt_lo_u32_b32 v51, -1, 0
    v_mfma_f32_16x16x32_bf16 v[4:7], a[116:119], a[232:235], v[4:7]
    s_add_u32 s0, s0, s63
    ds_read_b128 a[232:235], v36 offset:22528
    v_mbcnt_hi_u32_b32 v51, -1, v51
    v_mfma_f32_16x16x32_bf16 v[4:7], a[124:127], a[236:239], v[4:7]
    s_waitcnt lgkmcnt(6)
    ds_read_b128 a[236:239], v36 offset:23552
    v_and_b32 v52, 15, v51
    v_mfma_f32_16x16x32_bf16 v[0:3], a[128:131], a[208:211], v[0:3]
    v_lshrrev_b32 v53, 4, v51
    v_mul_u32_u24 v49, 272, v52
    s_lshl_b32 s56, s3, 6
    v_mfma_f32_16x16x32_bf16 v[0:3], a[136:139], a[212:215], v[0:3]
    buffer_load_dwordx4 v42, s[24:27], s54 offen offset:0 sc1 lds
    v_mfma_f32_16x16x32_bf16 v[4:7], a[132:135], a[208:211], v[4:7]
    s_add_u32 s56, s56, 79872
    ds_read_b128 a[208:211], v36 offset:24576
    v_mfma_f32_16x16x32_bf16 v[4:7], a[140:143], a[212:215], v[4:7]
    s_waitcnt lgkmcnt(6)
    ds_read_b128 a[212:215], v36 offset:25600
    v_add_u32 v36, 26624, v36
    v_mfma_f32_16x16x32_bf16 v[0:3], a[144:147], a[216:219], v[0:3]
    s_waitcnt vmcnt(6)
    buffer_store_dword v37, v45, s[24:27], s14 offen sc1
    v_mfma_f32_16x16x32_bf16 v[0:3], a[152:155], a[220:223], v[0:3]
    buffer_load_dwordx4 v42, s[24:27], s54 offen offset:1024 sc1 lds
    v_mfma_f32_16x16x32_bf16 v[4:7], a[148:151], a[216:219], v[4:7]
    buffer_store_dwordx4 v[28:31], v44, s[24:27], s1 offen sc1
    v_mfma_f32_16x16x32_bf16 v[4:7], a[156:159], a[220:223], v[4:7]
    s_waitcnt lgkmcnt(4)
    v_lshl_add_u32 v49, v53, 3, v49
    v_add_u32 v49, s56, v49
    v_mfma_f32_16x16x32_bf16 v[0:3], a[160:163], a[224:227], v[0:3]
    s_mov_b32 m0, s32
    v_mfma_f32_16x16x32_bf16 v[0:3], a[168:171], a[228:231], v[0:3]
    buffer_load_dwordx4 v42, s[24:27], s0 offen offset:0 sc1 lds
    s_lshl_b32 s56, s3, 2
    v_add_u32 v53, s56, v53
    v_lshlrev_b32 v54, 4, v52
    v_mul_u32_u24 v50, 272, v53
    v_add_u32 v50, v50, v54
    v_add_u32 v50, 79872, v50
    v_mul_u32_u24 v48, 1664, v53
    s_lshl_b32 s56, s48, 8
    v_add3_u32 v48, v48, v54, s56
    s_cmp_eq_u32 s48, 6
    s_cselect_b32 s56, 8, 16
    v_cmp_gt_u32 vcc, s56, v52
    v_mov_b32 v51, 2147483392
    s_nop 0
    v_cndmask_b32 v48, v51, v48, vcc
    s_waitcnt lgkmcnt(0)
    s_barrier
    v_mfma_f32_16x16x32_bf16 v[4:7], a[164:167], a[224:227], v[4:7]
    s_addk_i32 s14, 4096
    ds_read_b128 a[216:219], v36 offset:0
    ds_read_b128 v[28:31], v43 offset:0
    v_mfma_f32_16x16x32_bf16 v[4:7], a[172:175], a[228:231], v[4:7]
    ds_read_b128 a[220:223], v36 offset:1024
    v_lshlrev_b32 v33, 16, v24
    v_mfma_f32_16x16x32_bf16 v[0:3], a[176:179], a[232:235], v[0:3]
    ds_read_b128 a[224:227], v36 offset:2048
    v_and_b32 v35, s60, v24
    v_mfma_f32_16x16x32_bf16 v[0:3], a[184:187], a[236:239], v[0:3]
    ds_read_b128 a[228:231], v36 offset:3072
    v_mfma_f32_16x16x32_bf16 v[4:7], a[180:183], a[232:235], v[4:7]
    ds_read_b128 a[232:235], v36 offset:4096
    v_mfma_f32_16x16x32_bf16 v[4:7], a[188:191], a[236:239], v[4:7]
    ds_read_b128 a[236:239], v36 offset:5120
    v_mfma_f32_16x16x32_bf16 v[0:3], a[192:195], a[208:211], v[0:3]
    v_mfma_f32_16x16x32_bf16 v[0:3], a[200:203], a[212:215], v[0:3]
    s_waitcnt lgkmcnt(5)
    v_lshlrev_b32 v32, 16, v28
    v_and_b32 v34, s60, v28
    v_mfma_f32_16x16x32_bf16 v[4:7], a[196:199], a[208:211], v[4:7]
    ds_read_b128 a[208:211], v36 offset:6144
    v_mfma_f32_16x16x32_bf16 v[4:7], a[204:207], a[212:215], v[4:7]
    s_waitcnt lgkmcnt(5)
    ds_read_b128 a[212:215], v36 offset:7168
    v_mfma_f32_16x16x32_bf16 v[8:11], a[0:3], a[216:219], v[16:19]
    v_mfma_f32_16x16x32_bf16 v[8:11], a[8:11], a[220:223], v[8:11]
    v_fmac_f32 v33, v32, v0
    v_fmac_f32 v35, v34, v1
    v_mfma_f32_16x16x32_bf16 v[12:15], a[4:7], a[216:219], v[20:23]
    s_add_u32 s35, s35, s63
    ds_read_b128 a[216:219], v36 offset:8192
    v_cvt_pk_bf16_f32 v28, v33, v35
    v_mfma_f32_16x16x32_bf16 v[12:15], a[12:15], a[220:223], v[12:15]
    s_waitcnt lgkmcnt(5)
    ds_read_b128 a[220:223], v36 offset:9216
    v_lshlrev_b32 v33, 16, v25
    v_mfma_f32_16x16x32_bf16 v[8:11], a[16:19], a[224:227], v[8:11]
    v_and_b32 v35, s60, v25
    v_lshlrev_b32 v32, 16, v29
    v_mfma_f32_16x16x32_bf16 v[8:11], a[24:27], a[228:231], v[8:11]
    v_and_b32 v34, s60, v29
    v_fmac_f32 v33, v32, v2
    v_mfma_f32_16x16x32_bf16 v[12:15], a[20:23], a[224:227], v[12:15]
    ds_read_b128 a[224:227], v36 offset:10240
    v_fmac_f32 v35, v34, v3
    v_mfma_f32_16x16x32_bf16 v[12:15], a[28:31], a[228:231], v[12:15]
    s_waitcnt lgkmcnt(5)
    ds_read_b128 a[228:231], v36 offset:11264
    v_cvt_pk_bf16_f32 v29, v33, v35
    v_mfma_f32_16x16x32_bf16 v[8:11], a[32:35], a[232:235], v[8:11]
    s_mov_b32 m0, s68
    v_lshlrev_b32 v33, 16, v26
    v_and_b32 v35, s60, v26
    v_mfma_f32_16x16x32_bf16 v[8:11], a[40:43], a[236:239], v[8:11]
    v_lshlrev_b32 v32, 16, v30
    v_and_b32 v34, s60, v30
    v_mfma_f32_16x16x32_bf16 v[12:15], a[36:39], a[232:235], v[12:15]
    ds_read_b128 a[232:235], v36 offset:12288
    v_fmac_f32 v33, v32, v4
    v_mfma_f32_16x16x32_bf16 v[12:15], a[44:47], a[236:239], v[12:15]
    s_waitcnt lgkmcnt(5)
    ds_read_b128 a[236:239], v36 offset:13312
    v_fmac_f32 v35, v34, v5
    v_mfma_f32_16x16x32_bf16 v[8:11], a[48:51], a[208:211], v[8:11]
    v_cvt_pk_bf16_f32 v30, v33, v35
    ds_write_b64 v49, v[28:29] offset:0
    v_mfma_f32_16x16x32_bf16 v[8:11], a[56:59], a[212:215], v[8:11]
    s_waitcnt vmcnt(7)
    v_cmp_ne_u32 vcc, s45, v47
    s_cbranch_vccnz L_slow19
L_back19:
    v_mfma_f32_16x16x32_bf16 v[12:15], a[52:55], a[208:211], v[12:15]
    s_addk_i32 s49, 4096
    ds_read_b128 a[208:211], v36 offset:14336
    v_lshlrev_b32 v33, 16, v27
    v_mfma_f32_16x16x32_bf16 v[12:15], a[60:63], a[212:215], v[12:15]
    s_waitcnt lgkmcnt(6)
    ds_read_b128 a[212:215], v36 offset:15360
    v_and_b32 v35, s60, v27
    v_mfma_f32_16x16x32_bf16 v[8:11], a[64:67], a[216:219], v[8:11]
    buffer_load_dwordx4 v42, s[24:27], s35 offen offset:0 sc1 lds
    v_mfma_f32_16x16x32_bf16 v[8:11], a[72:75], a[220:223], v[8:11]
    ds_read_b128 v[24:27], v44 offset:53248
    v_lshlrev_b32 v32, 16, v31
    v_mfma_f32_16x16x32_bf16 v[12:15], a[68:71], a[216:219], v[12:15]
    ds_read_b128 a[216:219], v36 offset:16384
    v_and_b32 v34, s60, v31
    v_mfma_f32_16x16x32_bf16 v[12:15], a[76:79], a[220:223], v[12:15]
    s_waitcnt lgkmcnt(7)
    ds_read_b128 a[220:223], v36 offset:17408
    v_fmac_f32 v33, v32, v6
    v_mfma_f32_16x16x32_bf16 v[8:11], a[80:83], a[224:227], v[8:11]
    buffer_load_dwordx4 v42, s[24:27], s35 offen offset:1024 sc1 lds
    v_mfma_f32_16x16x32_bf16 v[8:11], a[88:91], a[228:231], v[8:11]
    buffer_load_dword v47, v46, s[24:27], s49 offen sc1
    v_mfma_f32_16x16x32_bf16 v[12:15], a[84:87], a[224:227], v[12:15]
    s_add_u32 s54, s35, s64
    ds_read_b128 a[224:227], v36 offset:18432
    v_fmac_f32 v35, v34, v7
    v_mfma_f32_16x16x32_bf16 v[12:15], a[92:95], a[228:231], v[12:15]
    s_waitcnt lgkmcnt(7)
    ds_read_b128 a[228:231], v36 offset:19456
    v_cvt_pk_bf16_f32 v31, v33, v35
    v_mfma_f32_16x16x32_bf16 v[8:11], a[96:99], a[232:235], v[8:11]
    buffer_load_dwordx4 v42, s[24:27], s35 offen offset:2048 sc1 lds
    v_mfma_f32_16x16x32_bf16 v[8:11], a[104:107], a[236:239], v[8:11]
    ds_write_b64 v49, v[30:31] offset:32
    v_mfma_f32_16x16x32_bf16 v[12:15], a[100:103], a[232:235], v[12:15]
    ds_read_b128 a[232:235], v36 offset:20480
    v_mfma_f32_16x16x32_bf16 v[12:15], a[108:111], a[236:239], v[12:15]
    s_waitcnt lgkmcnt(7)
    ds_read_b128 a[236:239], v36 offset:21504
    v_mfma_f32_16x16x32_bf16 v[8:11], a[112:115], a[208:211], v[8:11]
    buffer_load_dwordx4 v42, s[24:27], s35 offen offset:3072 sc1 lds
    v_mfma_f32_16x16x32_bf16 v[8:11], a[120:123], a[212:215], v[8:11]
    s_addk_i32 m0, 4096
    v_mfma_f32_16x16x32_bf16 v[12:15], a[116:119], a[208:211], v[12:15]
    s_add_u32 s0, s0, s63
    ds_read_b128 a[208:211], v36 offset:22528
    v_mfma_f32_16x16x32_bf16 v[12:15], a[124:127], a[212:215], v[12:15]
    s_waitcnt lgkmcnt(6)
    ds_read_b128 a[212:215], v36 offset:23552
    v_mfma_f32_16x16x32_bf16 v[8:11], a[128:131], a[216:219], v[8:11]
    v_mfma_f32_16x16x32_bf16 v[8:11], a[136:139], a[220:223], v[8:11]
    buffer_load_dwordx4 v42, s[24:27], s54 offen offset:0 sc1 lds
    v_mfma_f32_16x16x32_bf16 v[12:15], a[132:135], a[216:219], v[12:15]
    ds_read_b128 a[216:219], v36 offset:24576
    v_mfma_f32_16x16x32_bf16 v[12:15], a[140:143], a[220:223], v[12:15]
    s_waitcnt lgkmcnt(6)
    ds_read_b128 a[220:223], v36 offset:25600
    v_subrev_u32 v36, 53248, v36
    v_mfma_f32_16x16x32_bf16 v[8:11], a[144:147], a[224:227], v[8:11]
    s_waitcnt vmcnt(7)
    buffer_store_dword v37, v45, s[24:27], s14 offen sc1
    v_mfma_f32_16x16x32_bf16 v[8:11], a[152:155], a[228:231], v[8:11]
    buffer_load_dwordx4 v42, s[24:27], s54 offen offset:1024 sc1 lds
    v_mfma_f32_16x16x32_bf16 v[12:15], a[148:151], a[224:227], v[12:15]
    s_mov_b32 m0, s33
L_page6:
    s_cbranch_execz L_walk_back
    v_mfma_f32_16x16x32_bf16 v[12:15], a[156:159], a[228:231], v[12:15]
    s_waitcnt lgkmcnt(4)
    v_mfma_f32_16x16x32_bf16 v[8:11], a[160:163], a[232:235], v[8:11]
    v_mfma_f32_16x16x32_bf16 v[8:11], a[168:171], a[236:239], v[8:11]
    buffer_load_dwordx4 v42, s[24:27], s0 offen offset:0 sc1 lds
    s_waitcnt vmcnt(9) lgkmcnt(0)
    s_barrier
    v_mfma_f32_16x16x32_bf16 v[12:15], a[164:167], a[232:235], v[12:15]
    s_nop 0
    ds_read_b128 a[224:227], v36 offset:0
    ds_read_b128 v[28:31], v43 offset:4096
    v_mfma_f32_16x16x32_bf16 v[12:15], a[172:175], a[236:239], v[12:15]
    ds_read_b128 a[228:231], v36 offset:1024
    v_lshlrev_b32 v33, 16, v24
    v_mfma_f32_16x16x32_bf16 v[8:11], a[176:179], a[208:211], v[8:11]
    ds_read_b128 a[232:235], v36 offset:2048
    v_and_b32 v35, s60, v24
    v_mfma_f32_16x16x32_bf16 v[8:11], a[184:187], a[212:215], v[8:11]
    ds_read_b128 a[236:239], v36 offset:3072
    v_mfma_f32_16x16x32_bf16 v[12:15], a[180:183], a[208:211], v[12:15]
    s_nop 0
    ds_read_b128 a[208:211], v36 offset:4096
    ds_read_b128 v[52:55], v50 offset:0
    v_mfma_f32_16x16x32_bf16 v[12:15], a[188:191], a[212:215], v[12:15]
    ds_read_b128 a[212:215], v36 offset:5120
    v_mfma_f32_16x16x32_bf16 v[8:11], a[192:195], a[216:219], v[8:11]
    v_mfma_f32_16x16x32_bf16 v[8:11], a[200:203], a[220:223], v[8:11]
    s_waitcnt lgkmcnt(6)
    v_lshlrev_b32 v32, 16, v28
    v_and_b32 v34, s60, v28
    v_mfma_f32_16x16x32_bf16 v[12:15], a[196:199], a[216:219], v[12:15]
    ds_read_b128 a[216:219], v36 offset:6144
    v_mfma_f32_16x16x32_bf16 v[12:15], a[204:207], a[220:223], v[12:15]
    s_waitcnt lgkmcnt(6)
    ds_read_b128 a[220:223], v36 offset:7168
    v_mfma_f32_16x16x32_bf16 v[0:3], a[0:3], a[224:227], v[16:19]
    v_mfma_f32_16x16x32_bf16 v[0:3], a[8:11], a[228:231], v[0:3]
    v_fmac_f32 v33, v32, v8
    v_fmac_f32 v35, v34, v9
    v_mfma_f32_16x16x32_bf16 v[4:7], a[4:7], a[224:227], v[20:23]
    s_add_u32 s35, s35, s63
    ds_read_b128 a[224:227], v36 offset:8192
    v_cvt_pk_bf16_f32 v28, v33, v35
    v_mfma_f32_16x16x32_bf16 v[4:7], a[12:15], a[228:231], v[4:7]
    s_waitcnt lgkmcnt(6)
    ds_read_b128 a[228:231], v36 offset:9216
    v_lshlrev_b32 v33, 16, v25
    v_mfma_f32_16x16x32_bf16 v[0:3], a[16:19], a[232:235], v[0:3]
    s_waitcnt lgkmcnt(5)
    buffer_store_dwordx4 v[52:55], v48, s[28:31], s53 offen sc1 nt
    v_mfma_f32_16x16x32_bf16 v[0:3], a[24:27], a[236:239], v[0:3]
    v_and_b32 v35, s60, v25
    v_lshlrev_b32 v32, 16, v29
    v_mfma_f32_16x16x32_bf16 v[4:7], a[20:23], a[232:235], v[4:7]
    ds_read_b128 a[232:235], v36 offset:10240
    v_and_b32 v34, s60, v29
    v_mfma_f32_16x16x32_bf16 v[4:7], a[28:31], a[236:239], v[4:7]
    s_waitcnt lgkmcnt(5)
    ds_read_b128 a[236:239], v36 offset:11264
    v_fmac_f32 v33, v32, v10
    v_mfma_f32_16x16x32_bf16 v[0:3], a[32:35], a[208:211], v[0:3]
    s_mov_b32 m0, s69
    v_fmac_f32 v35, v34, v11
    v_cvt_pk_bf16_f32 v29, v33, v35
    v_mfma_f32_16x16x32_bf16 v[0:3], a[40:43], a[212:215], v[0:3]
    v_lshlrev_b32 v33, 16, v26
    v_and_b32 v35, s60, v26
    v_mfma_f32_16x16x32_bf16 v[4:7], a[36:39], a[208:211], v[4:7]
    ds_read_b128 a[208:211], v36 offset:12288
    v_lshlrev_b32 v32, 16, v30
    v_mfma_f32_16x16x32_bf16 v[4:7], a[44:47], a[212:215], v[4:7]
    s_waitcnt lgkmcnt(5)
    ds_read_b128 a[212:215], v36 offset:13312
    v_and_b32 v34, s60, v30
    v_mfma_f32_16x16x32_bf16 v[0:3], a[48:51], a[216:219], v[0:3]
    v_fmac_f32 v33, v32, v12
    v_fmac_f32 v35, v34, v13
    v_mfma_f32_16x16x32_bf16 v[0:3], a[56:59], a[220:223], v[0:3]
    s_waitcnt vmcnt(7)
    v_cmp_ne_u32 vcc, s45, v47
    s_cbranch_vccnz L_slow20
L_back20:
    v_mfma_f32_16x16x32_bf16 v[4:7], a[52:55], a[216:219], v[4:7]
    s_addk_i32 s49, 4096
    ds_read_b128 a[216:219], v36 offset:14336
    v_cvt_pk_bf16_f32 v30, v33, v35
    v_mfma_f32_16x16x32_bf16 v[4:7], a[60:63], a[220:223], v[4:7]
    s_waitcnt lgkmcnt(5)
    ds_read_b128 a[220:223], v36 offset:15360
    ds_write_b64 v49, v[28:29] offset:8192
    v_mfma_f32_16x16x32_bf16 v[0:3], a[64:67], a[224:227], v[0:3]
    buffer_load_dwordx4 v42, s[24:27], s35 offen offset:0 sc1 lds
    v_mfma_f32_16x16x32_bf16 v[0:3], a[72:75], a[228:231], v[0:3]
    v_lshlrev_b32 v33, 16, v27
    v_and_b32 v35, s60, v27
    v_mfma_f32_16x16x32_bf16 v[4:7], a[68:71], a[224:227], v[4:7]
    s_nop 0
    ds_read_b128 a[224:227], v36 offset:16384
    ds_read_b128 v[24:27], v44 offset:0
    v_mfma_f32_16x16x32_bf16 v[4:7], a[76:79], a[228:231], v[4:7]
    s_waitcnt lgkmcnt(7)
    ds_read_b128 a[228:231], v36 offset:17408
    v_lshlrev_b32 v32, 16, v31
    v_mfma_f32_16x16x32_bf16 v[0:3], a[80:83], a[232:235], v[0:3]
    buffer_load_dwordx4 v42, s[24:27], s35 offen offset:1024 sc1 lds
    v_mfma_f32_16x16x32_bf16 v[0:3], a[88:91], a[236:239], v[0:3]
    buffer_load_dword v47, v46, s[24:27], s49 offen sc1
    v_mfma_f32_16x16x32_bf16 v[4:7], a[84:87], a[232:235], v[4:7]
    s_add_u32 s54, s35, s64
    ds_read_b128 a[232:235], v36 offset:18432
    v_and_b32 v34, s60, v31
    v_mfma_f32_16x16x32_bf16 v[4:7], a[92:95], a[236:239], v[4:7]
    s_waitcnt lgkmcnt(7)
    ds_read_b128 a[236:239], v36 offset:19456
    v_fmac_f32 v33, v32, v14
    v_mfma_f32_16x16x32_bf16 v[0:3], a[96:99], a[208:211], v[0:3]
    buffer_load_dwordx4 v42, s[24:27], s35 offen offset:2048 sc1 lds
    v_mfma_f32_16x16x32_bf16 v[0:3], a[104:107], a[212:215], v[0:3]
    v_fmac_f32 v35, v34, v15
    v_cvt_pk_bf16_f32 v31, v33, v35
    v_mfma_f32_16x16x32_bf16 v[4:7], a[100:103], a[208:211], v[4:7]
    s_nop 0
    ds_read_b128 a[208:211], v36 offset:20480
    ds_write_b64 v49, v[30:31] offset:8224
    v_mfma_f32_16x16x32_bf16 v[4:7], a[108:111], a[212:215], v[4:7]
    s_waitcnt lgkmcnt(8)
    ds_read_b128 a[212:215], v36 offset:21504
    v_mfma_f32_16x16x32_bf16 v[0:3], a[112:115], a[216:219], v[0:3]
    buffer_load_dwordx4 v42, s[24:27], s35 offen offset:3072 sc1 lds
    v_mfma_f32_16x16x32_bf16 v[0:3], a[120:123], a[220:223], v[0:3]
    s_addk_i32 m0, 4096
    v_mfma_f32_16x16x32_bf16 v[4:7], a[116:119], a[216:219], v[4:7]
    s_add_u32 s0, s0, s63
    ds_read_b128 a[216:219], v36 offset:22528
    v_mfma_f32_16x16x32_bf16 v[4:7], a[124:127], a[220:223], v[4:7]
    s_waitcnt lgkmcnt(6)
    ds_read_b128 a[220:223], v36 offset:23552
    v_mfma_f32_16x16x32_bf16 v[0:3], a[128:131], a[224:227], v[0:3]
    v_mfma_f32_16x16x32_bf16 v[0:3], a[136:139], a[228:231], v[0:3]
    buffer_load_dwordx4 v42, s[24:27], s54 offen offset:0 sc1 lds
    v_mfma_f32_16x16x32_bf16 v[4:7], a[132:135], a[224:227], v[4:7]
    ds_read_b128 a[224:227], v36 offset:24576
    v_mfma_f32_16x16x32_bf16 v[4:7], a[140:143], a[228:231], v[4:7]
    s_waitcnt lgkmcnt(6)
    ds_read_b128 a[228:231], v36 offset:25600
    v_add_u32 v36, 26624, v36
    v_mfma_f32_16x16x32_bf16 v[0:3], a[144:147], a[232:235], v[0:3]
    v_mfma_f32_16x16x32_bf16 v[0:3], a[152:155], a[236:239], v[0:3]
    buffer_load_dwordx4 v42, s[24:27], s54 offen offset:1024 sc1 lds
    v_mfma_f32_16x16x32_bf16 v[4:7], a[148:151], a[232:235], v[4:7]
    s_mov_b32 m0, s34
    v_mfma_f32_16x16x32_bf16 v[4:7], a[156:159], a[236:239], v[4:7]
    s_waitcnt lgkmcnt(4)
    v_mfma_f32_16x16x32_bf16 v[0:3], a[160:163], a[208:211], v[0:3]
    v_mfma_f32_16x16x32_bf16 v[0:3], a[168:171], a[212:215], v[0:3]
    buffer_load_dwordx4 v42, s[24:27], s0 offen offset:0 sc1 lds
    s_waitcnt vmcnt(9) lgkmcnt(0)
    s_barrier
    v_mfma_f32_16x16x32_bf16 v[4:7], a[164:167], a[208:211], v[4:7]
    s_nop 0
    ds_read_b128 a[232:235], v36 offset:0
    ds_read_b128 v[28:31], v43 offset:8192
    v_mfma_f32_16x16x32_bf16 v[4:7], a[172:175], a[212:215], v[4:7]
    ds_read_b128 a[236:239], v36 offset:1024
    v_lshlrev_b32 v33, 16, v24
    v_mfma_f32_16x16x32_bf16 v[0:3], a[176:179], a[216:219], v[0:3]
    ds_read_b128 a[208:211], v36 offset:2048
    v_and_b32 v35, s60, v24
    v_mfma_f32_16x16x32_bf16 v[0:3], a[184:187], a[220:223], v[0:3]
    ds_read_b128 a[212:215], v36 offset:3072
    v_mfma_f32_16x16x32_bf16 v[4:7], a[180:183], a[216:219], v[4:7]
    ds_read_b128 a[216:219], v36 offset:4096
    ds_read_b128 v[52:55], v50 offset:8192
    s_add_u32 s53, s53, s63
    v_mfma_f32_16x16x32_bf16 v[4:7], a[188:191], a[220:223], v[4:7]
    ds_read_b128 a[220:223], v36 offset:5120
    v_mfma_f32_16x16x32_bf16 v[0:3], a[192:195], a[224:227], v[0:3]
    v_mfma_f32_16x16x32_bf16 v[0:3], a[200:203], a[228:231], v[0:3]
    s_waitcnt lgkmcnt(6)
    v_lshlrev_b32 v32, 16, v28
    v_and_b32 v34, s60, v28
    v_mfma_f32_16x16x32_bf16 v[4:7], a[196:199], a[224:227], v[4:7]
    ds_read_b128 a[224:227], v36 offset:6144
    v_mfma_f32_16x16x32_bf16 v[4:7], a[204:207], a[228:231], v[4:7]
    s_waitcnt lgkmcnt(6)
    ds_read_b128 a[228:231], v36 offset:7168
    v_mfma_f32_16x16x32_bf16 v[8:11], a[0:3], a[232:235], v[16:19]
    v_mfma_f32_16x16x32_bf16 v[8:11], a[8:11], a[236:239], v[8:11]
    v_fmac_f32 v33, v32, v0
    v_fmac_f32 v35, v34, v1
    v_mfma_f32_16x16x32_bf16 v[12:15], a[4:7], a[232:235], v[20:23]
    s_add_u32 s35, s35, s63
    ds_read_b128 a[232:235], v36 offset:8192
    v_cvt_pk_bf16_f32 v28, v33, v35
    v_mfma_f32_16x16x32_bf16 v[12:15], a[12:15], a[236:239], v[12:15]
    s_waitcnt lgkmcnt(6)
    ds_read_b128 a[236:239], v36 offset:9216
    v_lshlrev_b32 v33, 16, v25
    v_mfma_f32_16x16x32_bf16 v[8:11], a[16:19], a[208:211], v[8:11]
    s_waitcnt lgkmcnt(5)
    buffer_store_dwordx4 v[52:55], v48, s[28:31], s53 offen sc1 nt
    v_mfma_f32_16x16x32_bf16 v[8:11], a[24:27], a[212:215], v[8:11]
    v_and_b32 v35, s60, v25
    v_lshlrev_b32 v32, 16, v29
    v_mfma_f32_16x16x32_bf16 v[12:15], a[20:23], a[208:211], v[12:15]
    ds_read_b128 a[208:211], v36 offset:10240
    v_and_b32 v34, s60, v29
    v_mfma_f32_16x16x32_bf16 v[12:15], a[28:31], a[212:215], v[12:15]
    s_waitcnt lgkmcnt(5)
    ds_read_b128 a[212:215], v36 offset:11264
    v_fmac_f32 v33, v32, v2
    v_mfma_f32_16x16x32_bf16 v[8:11], a[32:35], a[216:219], v[8:11]
    s_mov_b32 m0, s67
    v_fmac_f32 v35, v34, v3
    v_cvt_pk_bf16_f32 v29, v33, v35
    v_mfma_f32_16x16x32_bf16 v[8:11], a[40:43], a[220:223], v[8:11]
    v_lshlrev_b32 v33, 16, v26
    v_and_b32 v35, s60, v26
    v_mfma_f32_16x16x32_bf16 v[12:15], a[36:39], a[216:219], v[12:15]
    ds_read_b128 a[216:219], v36 offset:12288
    v_lshlrev_b32 v32, 16, v30
    v_mfma_f32_16x16x32_bf16 v[12:15], a[44:47], a[220:223], v[12:15]
    s_waitcnt lgkmcnt(5)
    ds_read_b128 a[220:223], v36 offset:13312
    v_and_b32 v34, s60, v30
    v_mfma_f32_16x16x32_bf16 v[8:11], a[48:51], a[224:227], v[8:11]
    v_fmac_f32 v33, v32, v4
    v_fmac_f32 v35, v34, v5
    v_mfma_f32_16x16x32_bf16 v[8:11], a[56:59], a[228:231], v[8:11]
    s_waitcnt vmcnt(6)
    v_cmp_ne_u32 vcc, s45, v47
    s_cbranch_vccnz L_slow21
L_back21:
    v_mfma_f32_16x16x32_bf16 v[12:15], a[52:55], a[224:227], v[12:15]
    s_addk_i32 s49, 4096
    ds_read_b128 a[224:227], v36 offset:14336
    v_cvt_pk_bf16_f32 v30, v33, v35
    v_mfma_f32_16x16x32_bf16 v[12:15], a[60:63], a[228:231], v[12:15]
    s_waitcnt lgkmcnt(5)
    ds_read_b128 a[228:231], v36 offset:15360
    ds_write_b64 v49, v[28:29] offset:0
    v_mfma_f32_16x16x32_bf16 v[8:11], a[64:67], a[232:235], v[8:11]
    buffer_load_dwordx4 v42, s[24:27], s35 offen offset:0 sc1 lds
    v_mfma_f32_16x16x32_bf16 v[8:11], a[72:75], a[236:239], v[8:11]
    v_lshlrev_b32 v33, 16, v27
    v_and_b32 v35, s60, v27
    v_mfma_f32_16x16x32_bf16 v[12:15], a[68:71], a[232:235], v[12:15]
    s_nop 0
    ds_read_b128 a[232:235], v36 offset:16384
    ds_read_b128 v[24:27], v44 offset:26624
    v_mfma_f32_16x16x32_bf16 v[12:15], a[76:79], a[236:239], v[12:15]
    s_waitcnt lgkmcnt(7)
    ds_read_b128 a[236:239], v36 offset:17408
    v_lshlrev_b32 v32, 16, v31
    v_mfma_f32_16x16x32_bf16 v[8:11], a[80:83], a[208:211], v[8:11]
    buffer_load_dwordx4 v42, s[24:27], s35 offen offset:1024 sc1 lds
    v_mfma_f32_16x16x32_bf16 v[8:11], a[88:91], a[212:215], v[8:11]
    buffer_load_dword v47, v46, s[24:27], s49 offen sc1
    v_mfma_f32_16x16x32_bf16 v[12:15], a[84:87], a[208:211], v[12:15]
    s_add_u32 s54, s35, s64
    ds_read_b128 a[208:211], v36 offset:18432
    v_and_b32 v34, s60, v31
    v_mfma_f32_16x16x32_bf16 v[12:15], a[92:95], a[212:215], v[12:15]
    s_waitcnt lgkmcnt(7)
    ds_read_b128 a[212:215], v36 offset:19456
    v_fmac_f32 v33, v32, v6
    v_mfma_f32_16x16x32_bf16 v[8:11], a[96:99], a[216:219], v[8:11]
    buffer_load_dwordx4 v42, s[24:27], s35 offen offset:2048 sc1 lds
    v_mfma_f32_16x16x32_bf16 v[8:11], a[104:107], a[220:223], v[8:11]
    v_fmac_f32 v35, v34, v7
    v_cvt_pk_bf16_f32 v31, v33, v35
    v_mfma_f32_16x16x32_bf16 v[12:15], a[100:103], a[216:219], v[12:15]
    s_nop 0
    ds_read_b128 a[216:219], v36 offset:20480
    ds_write_b64 v49, v[30:31] offset:32
    v_mfma_f32_16x16x32_bf16 v[12:15], a[108:111], a[220:223], v[12:15]
    s_waitcnt lgkmcnt(8)
    ds_read_b128 a[220:223], v36 offset:21504
    v_mfma_f32_16x16x32_bf16 v[8:11], a[112:115], a[224:227], v[8:11]
    buffer_load_dwordx4 v42, s[24:27], s35 offen offset:3072 sc1 lds
    v_mfma_f32_16x16x32_bf16 v[8:11], a[120:123], a[228:231], v[8:11]
    s_addk_i32 m0, 4096
    v_mfma_f32_16x16x32_bf16 v[12:15], a[116:119], a[224:227], v[12:15]
    s_add_u32 s0, s0, s63
    ds_read_b128 a[224:227], v36 offset:22528
    v_mfma_f32_16x16x32_bf16 v[12:15], a[124:127], a[228:231], v[12:15]
    s_waitcnt lgkmcnt(6)
    ds_read_b128 a[228:231], v36 offset:23552
    v_mfma_f32_16x16x32_bf16 v[8:11], a[128:131], a[232:235], v[8:11]
    v_mfma_f32_16x16x32_bf16 v[8:11], a[136:139], a[236:239], v[8:11]
    buffer_load_dwordx4 v42, s[24:27], s54 offen offset:0 sc1 lds
    v_mfma_f32_16x16x32_bf16 v[12:15], a[132:135], a[232:235], v[12:15]
    ds_read_b128 a[232:235], v36 offset:24576
    v_mfma_f32_16x16x32_bf16 v[12:15], a[140:143], a[236:239], v[12:15]
    s_waitcnt lgkmcnt(6)
    ds_read_b128 a[236:239], v36 offset:25600
    v_add_u32 v36, 26624, v36
    v_mfma_f32_16x16x32_bf16 v[8:11], a[144:147], a[208:211], v[8:11]
    v_mfma_f32_16x16x32_bf16 v[8:11], a[152:155], a[212:215], v[8:11]
    buffer_load_dwordx4 v42, s[24:27], s54 offen offset:1024 sc1 lds
    v_mfma_f32_16x16x32_bf16 v[12:15], a[148:151], a[208:211], v[12:15]
    s_mov_b32 m0, s32
    v_mfma_f32_16x16x32_bf16 v[12:15], a[156:159], a[212:215], v[12:15]
    s_waitcnt lgkmcnt(4)
    v_mfma_f32_16x16x32_bf16 v[8:11], a[160:163], a[216:219], v[8:11]
    v_mfma_f32_16x16x32_bf16 v[8:11], a[168:171], a[220:223], v[8:11]
    buffer_load_dwordx4 v42, s[24:27], s0 offen offset:0 sc1 lds
    s_waitcnt vmcnt(9) lgkmcnt(0)
    s_barrier
    v_mfma_f32_16x16x32_bf16 v[12:15], a[164:167], a[216:219], v[12:15]
    s_nop 0
    ds_read_b128 a[208:211], v36 offset:0
    ds_read_b128 v[28:31], v43 offset:12288
    v_mfma_f32_16x16x32_bf16 v[12:15], a[172:175], a[220:223], v[12:15]
    ds_read_b128 a[212:215], v36 offset:1024
    v_lshlrev_b32 v33, 16, v24
    v_mfma_f32_16x16x32_bf16 v[8:11], a[176:179], a[224:227], v[8:11]
    ds_read_b128 a[216:219], v36 offset:2048
    v_and_b32 v35, s60, v24
    v_mfma_f32_16x16x32_bf16 v[8:11], a[184:187], a[228:231], v[8:11]
    ds_read_b128 a[220:223], v36 offset:3072
    v_mfma_f32_16x16x32_bf16 v[12:15], a[180:183], a[224:227], v[12:15]
    ds_read_b128 a[224:227], v36 offset:4096
    ds_read_b128 v[52:55], v50 offset:0
    s_add_u32 s53, s53, s63
    v_mfma_f32_16x16x32_bf16 v[12:15], a[188:191], a[228:231], v[12:15]
    ds_read_b128 a[228:231], v36 offset:5120
    v_mfma_f32_16x16x32_bf16 v[8:11], a[192:195], a[232:235], v[8:11]
    v_mfma_f32_16x16x32_bf16 v[8:11], a[200:203], a[236:239], v[8:11]
    s_waitcnt lgkmcnt(6)
    v_lshlrev_b32 v32, 16, v28
    v_and_b32 v34, s60, v28
    v_mfma_f32_16x16x32_bf16 v[12:15], a[196:199], a[232:235], v[12:15]
    ds_read_b128 a[232:235], v36 offset:6144
    v_mfma_f32_16x16x32_bf16 v[12:15], a[204:207], a[236:239], v[12:15]
    s_waitcnt lgkmcnt(6)
    ds_read_b128 a[236:239], v36 offset:7168
    v_mfma_f32_16x16x32_bf16 v[0:3], a[0:3], a[208:211], v[16:19]
    v_mfma_f32_16x16x32_bf16 v[0:3], a[8:11], a[212:215], v[0:3]
    v_fmac_f32 v33, v32, v8
    v_fmac_f32 v35, v34, v9
    v_mfma_f32_16x16x32_bf16 v[4:7], a[4:7], a[208:211], v[20:23]
    s_add_u32 s35, s35, s63
    ds_read_b128 a[208:211], v36 offset:8192
    v_cvt_pk_bf16_f32 v28, v33, v35
    v_mfma_f32_16x16x32_bf16 v[4:7], a[12:15], a[212:215], v[4:7]
    s_waitcnt lgkmcnt(6)
    ds_read_b128 a[212:215], v36 offset:9216
    v_lshlrev_b32 v33, 16, v25
    v_mfma_f32_16x16x32_bf16 v[0:3], a[16:19], a[216:219], v[0:3]
    s_waitcnt lgkmcnt(5)
    buffer_store_dwordx4 v[52:55], v48, s[28:31], s53 offen sc1 nt
    v_mfma_f32_16x16x32_bf16 v[0:3], a[24:27], a[220:223], v[0:3]
    v_and_b32 v35, s60, v25
    v_lshlrev_b32 v32, 16, v29
    v_mfma_f32_16x16x32_bf16 v[4:7], a[20:23], a[216:219], v[4:7]
    ds_read_b128 a[216:219], v36 offset:10240
    v_and_b32 v34, s60, v29
    v_mfma_f32_16x16x32_bf16 v[4:7], a[28:31], a[220:223], v[4:7]
    s_waitcnt lgkmcnt(5)
    ds_read_b128 a[220:223], v36 offset:11264
    v_fmac_f32 v33, v32, v10
    v_mfma_f32_16x16x32_bf16 v[0:3], a[32:35], a[224:227], v[0:3]
    s_mov_b32 m0, s68
    v_fmac_f32 v35, v34, v11
    v_cvt_pk_bf16_f32 v29, v33, v35
    v_mfma_f32_16x16x32_bf16 v[0:3], a[40:43], a[228:231], v[0:3]
    v_lshlrev_b32 v33, 16, v26
    v_and_b32 v35, s60, v26
    v_mfma_f32_16x16x32_bf16 v[4:7], a[36:39], a[224:227], v[4:7]
    ds_read_b128 a[224:227], v36 offset:12288
    v_lshlrev_b32 v32, 16, v30
    v_mfma_f32_16x16x32_bf16 v[4:7], a[44:47], a[228:231], v[4:7]
    s_waitcnt lgkmcnt(5)
    ds_read_b128 a[228:231], v36 offset:13312
    v_and_b32 v34, s60, v30
    v_mfma_f32_16x16x32_bf16 v[0:3], a[48:51], a[232:235], v[0:3]
    v_fmac_f32 v33, v32, v12
    v_fmac_f32 v35, v34, v13
    v_mfma_f32_16x16x32_bf16 v[0:3], a[56:59], a[236:239], v[0:3]
    s_waitcnt vmcnt(6)
    v_cmp_ne_u32 vcc, s45, v47
    s_cbranch_vccnz L_slow22
L_back22:
    v_mfma_f32_16x16x32_bf16 v[4:7], a[52:55], a[232:235], v[4:7]
    s_addk_i32 s49, 4096
    ds_read_b128 a[232:235], v36 offset:14336
    v_cvt_pk_bf16_f32 v30, v33, v35
    v_mfma_f32_16x16x32_bf16 v[4:7], a[60:63], a[236:239], v[4:7]
    s_waitcnt lgkmcnt(5)
    ds_read_b128 a[236:239], v36 offset:15360
    ds_write_b64 v49, v[28:29] offset:8192
    v_mfma_f32_16x16x32_bf16 v[0:3], a[64:67], a[208:211], v[0:3]
    buffer_load_dwordx4 v42, s[24:27], s35 offen offset:0 sc1 lds
    v_mfma_f32_16x16x32_bf16 v[0:3], a[72:75], a[212:215], v[0:3]
    v_lshlrev_b32 v33, 16, v27
    v_and_b32 v35, s60, v27
    v_mfma_f32_16x16x32_bf16 v[4:7], a[68:71], a[208:211], v[4:7]
    s_nop 0
    ds_read_b128 a[208:211], v36 offset:16384
    ds_read_b128 v[24:27], v44 offset:53248
    v_mfma_f32_16x16x32_bf16 v[4:7], a[76:79], a[212:215], v[4:7]
    s_waitcnt lgkmcnt(7)
    ds_read_b128 a[212:215], v36 offset:17408
    v_lshlrev_b32 v32, 16, v31
    v_mfma_f32_16x16x32_bf16 v[0:3], a[80:83], a[216:219], v[0:3]
    buffer_load_dwordx4 v42, s[24:27], s35 offen offset:1024 sc1 lds
    v_mfma_f32_16x16x32_bf16 v[0:3], a[88:91], a[220:223], v[0:3]
    buffer_load_dword v47, v46, s[24:27], s49 offen sc1
    v_mfma_f32_16x16x32_bf16 v[4:7], a[84:87], a[216:219], v[4:7]
    s_add_u32 s54, s35, s64
    ds_read_b128 a[216:219], v36 offset:18432
    v_and_b32 v34, s60, v31
    v_mfma_f32_16x16x32_bf16 v[4:7], a[92:95], a[220:223], v[4:7]
    s_waitcnt lgkmcnt(7)
    ds_read_b128 a[220:223], v36 offset:19456
    v_fmac_f32 v33, v32, v14
    v_mfma_f32_16x16x32_bf16 v[0:3], a[96:99], a[224:227], v[0:3]
    buffer_load_dwordx4 v42, s[24:27], s35 offen offset:2048 sc1 lds
    v_mfma_f32_16x16x32_bf16 v[0:3], a[104:107], a[228:231], v[0:3]
    v_fmac_f32 v35, v34, v15
    v_cvt_pk_bf16_f32 v31, v33, v35
    v_mfma_f32_16x16x32_bf16 v[4:7], a[100:103], a[224:227], v[4:7]
    s_nop 0
    ds_read_b128 a[224:227], v36 offset:20480
    ds_write_b64 v49, v[30:31] offset:8224
    v_mfma_f32_16x16x32_bf16 v[4:7], a[108:111], a[228:231], v[4:7]
    s_waitcnt lgkmcnt(8)
    ds_read_b128 a[228:231], v36 offset:21504
    v_mfma_f32_16x16x32_bf16 v[0:3], a[112:115], a[232:235], v[0:3]
    buffer_load_dwordx4 v42, s[24:27], s35 offen offset:3072 sc1 lds
    v_mfma_f32_16x16x32_bf16 v[0:3], a[120:123], a[236:239], v[0:3]
    s_addk_i32 m0, 4096
    v_mfma_f32_16x16x32_bf16 v[4:7], a[116:119], a[232:235], v[4:7]
    s_add_u32 s0, s0, s63
    ds_read_b128 a[232:235], v36 offset:22528
    v_mfma_f32_16x16x32_bf16 v[4:7], a[124:127], a[236:239], v[4:7]
    s_waitcnt lgkmcnt(6)
    ds_read_b128 a[236:239], v36 offset:23552
    v_mfma_f32_16x16x32_bf16 v[0:3], a[128:131], a[208:211], v[0:3]
    v_mfma_f32_16x16x32_bf16 v[0:3], a[136:139], a[212:215], v[0:3]
    buffer_load_dwordx4 v42, s[24:27], s54 offen offset:0 sc1 lds
    v_mfma_f32_16x16x32_bf16 v[4:7], a[132:135], a[208:211], v[4:7]
    ds_read_b128 a[208:211], v36 offset:24576
    v_mfma_f32_16x16x32_bf16 v[4:7], a[140:143], a[212:215], v[4:7]
    s_waitcnt lgkmcnt(6)
    ds_read_b128 a[212:215], v36 offset:25600
    v_subrev_u32 v36, 53248, v36
    v_mfma_f32_16x16x32_bf16 v[0:3], a[144:147], a[216:219], v[0:3]
    v_mfma_f32_16x16x32_bf16 v[0:3], a[152:155], a[220:223], v[0:3]
    buffer_load_dwordx4 v42, s[24:27], s54 offen offset:1024 sc1 lds
    v_mfma_f32_16x16x32_bf16 v[4:7], a[148:151], a[216:219], v[4:7]
    s_mov_b32 m0, s33
    v_mfma_f32_16x16x32_bf16 v[4:7], a[156:159], a[220:223], v[4:7]
    s_waitcnt lgkmcnt(4)
    v_mfma_f32_16x16x32_bf16 v[0:3], a[160:163], a[224:227], v[0:3]
    v_mfma_f32_16x16x32_bf16 v[0:3], a[168:171], a[228:231], v[0:3]
    buffer_load_dwordx4 v42, s[24:27], s0 offen offset:0 sc1 lds
    s_waitcnt vmcnt(9) lgkmcnt(0)
    s_barrier
    v_mfma_f32_16x16x32_bf16 v[4:7], a[164:167], a[224:227], v[4:7]
    ds_read_b128 a[216:219], v36 offset:0
    v_accvgpr_read_b32 v28, a240
    v_mfma_f32_16x16x32_bf16 v[4:7], a[172:175], a[228:231], v[4:7]
    ds_read_b128 a[220:223], v36 offset:1024
    v_accvgpr_read_b32 v29, a241
    v_mfma_f32_16x16x32_bf16 v[0:3], a[176:179], a[232:235], v[0:3]
    ds_read_b128 a[224:227], v36 offset:2048
    v_accvgpr_read_b32 v30, a242
    v_mfma_f32_16x16x32_bf16 v[0:3], a[184:187], a[236:239], v[0:3]
    ds_read_b128 a[228:231], v36 offset:3072
    v_accvgpr_read_b32 v31, a243
    v_mfma_f32_16x16x32_bf16 v[4:7], a[180:183], a[232:235], v[4:7]
    ds_read_b128 a[232:235], v36 offset:4096
    ds_read_b128 v[52:55], v50 offset:8192
    s_add_u32 s53, s53, s63
    v_mfma_f32_16x16x32_bf16 v[4:7], a[188:191], a[236:239], v[4:7]
    ds_read_b128 a[236:239], v36 offset:5120
    v_lshlrev_b32 v33, 16, v24
    v_mfma_f32_16x16x32_bf16 v[0:3], a[192:195], a[208:211], v[0:3]
    v_and_b32 v35, s60, v24
    v_lshlrev_b32 v32, 16, v28
    v_mfma_f32_16x16x32_bf16 v[0:3], a[200:203], a[212:215], v[0:3]
    v_and_b32 v34, s60, v28
    v_mfma_f32_16x16x32_bf16 v[4:7], a[196:199], a[208:211], v[4:7]
    ds_read_b128 a[208:211], v36 offset:6144
    v_mfma_f32_16x16x32_bf16 v[4:7], a[204:207], a[212:215], v[4:7]
    s_waitcnt lgkmcnt(6)
    ds_read_b128 a[212:215], v36 offset:7168
    v_mfma_f32_16x16x32_bf16 v[8:11], a[0:3], a[216:219], v[16:19]
    v_mfma_f32_16x16x32_bf16 v[8:11], a[8:11], a[220:223], v[8:11]
    v_fmac_f32 v33, v32, v0
    v_fmac_f32 v35, v34, v1
    v_mfma_f32_16x16x32_bf16 v[12:15], a[4:7], a[216:219], v[20:23]
    s_add_u32 s35, s35, s63
    ds_read_b128 a[216:219], v36 offset:8192
    v_cvt_pk_bf16_f32 v28, v33, v35
    v_mfma_f32_16x16x32_bf16 v[12:15], a[12:15], a[220:223], v[12:15]
    s_waitcnt lgkmcnt(6)
    ds_read_b128 a[220:223], v36 offset:9216
    v_lshlrev_b32 v33, 16, v25
    v_mfma_f32_16x16x32_bf16 v[8:11], a[16:19], a[224:227], v[8:11]
    s_waitcnt lgkmcnt(5)
    buffer_store_dwordx4 v[52:55], v48, s[28:31], s53 offen sc1 nt
    v_mfma_f32_16x16x32_bf16 v[8:11], a[24:27], a[228:231], v[8:11]
    v_and_b32 v35, s60, v25
    v_lshlrev_b32 v32, 16, v29
    v_mfma_f32_16x16x32_bf16 v[12:15], a[20:23], a[224:227], v[12:15]
    ds_read_b128 a[224:227], v36 offset:10240
    v_and_b32 v34, s60, v29
    v_mfma_f32_16x16x32_bf16 v[12:15], a[28:31], a[228:231], v[12:15]
    s_waitcnt lgkmcnt(5)
    ds_read_b128 a[228:231], v36 offset:11264
    v_fmac_f32 v33, v32, v2
    v_mfma_f32_16x16x32_bf16 v[8:11], a[32:35], a[232:235], v[8:11]
    s_mov_b32 m0, s69
    v_fmac_f32 v35, v34, v3
    v_cvt_pk_bf16_f32 v29, v33, v35
    v_mfma_f32_16x16x32_bf16 v[8:11], a[40:43], a[236:239], v[8:11]
    v_lshlrev_b32 v33, 16, v26
    v_and_b32 v35, s60, v26
    v_mfma_f32_16x16x32_bf16 v[12:15], a[36:39], a[232:235], v[12:15]
    ds_read_b128 a[232:235], v36 offset:12288
    v_lshlrev_b32 v32, 16, v30
    v_mfma_f32_16x16x32_bf16 v[12:15], a[44:47], a[236:239], v[12:15]
    s_waitcnt lgkmcnt(5)
    ds_read_b128 a[236:239], v36 offset:13312
    v_and_b32 v34, s60, v30
    v_mfma_f32_16x16x32_bf16 v[8:11], a[48:51], a[208:211], v[8:11]
    v_fmac_f32 v33, v32, v4
    v_fmac_f32 v35, v34, v5
    v_mfma_f32_16x16x32_bf16 v[8:11], a[56:59], a[212:215], v[8:11]
    s_waitcnt vmcnt(6)
    v_cmp_ne_u32 vcc, s45, v47
    s_cbranch_vccnz L_slow23
L_back23:
    v_mfma_f32_16x16x32_bf16 v[12:15], a[52:55], a[208:211], v[12:15]
    ds_read_b128 a[208:211], v36 offset:14336
    v_cvt_pk_bf16_f32 v30, v33, v35
    v_mfma_f32_16x16x32_bf16 v[12:15], a[60:63], a[212:215], v[12:15]
    s_waitcnt lgkmcnt(5)
    ds_read_b128 a[212:215], v36 offset:15360
    ds_write_b64 v49, v[28:29] offset:0
    v_mfma_f32_16x16x32_bf16 v[8:11], a[64:67], a[216:219], v[8:11]
    buffer_load_dwordx4 v42, s[24:27], s35 offen offset:0 sc1 lds
    v_mfma_f32_16x16x32_bf16 v[8:11], a[72:75], a[220:223], v[8:11]
    v_lshlrev_b32 v33, 16, v27
    v_and_b32 v35, s60, v27
    v_mfma_f32_16x16x32_bf16 v[12:15], a[68:71], a[216:219], v[12:15]
    s_nop 0
    ds_read_b128 a[216:219], v36 offset:16384
    ds_read_b128 v[24:27], v44 offset:0
    v_mfma_f32_16x16x32_bf16 v[12:15], a[76:79], a[220:223], v[12:15]
    s_waitcnt lgkmcnt(7)
    ds_read_b128 a[220:223], v36 offset:17408
    v_lshlrev_b32 v32, 16, v31
    v_mfma_f32_16x16x32_bf16 v[8:11], a[80:83], a[224:227], v[8:11]
    buffer_load_dwordx4 v42, s[24:27], s35 offen offset:1024 sc1 lds
    v_mfma_f32_16x16x32_bf16 v[8:11], a[88:91], a[228:231], v[8:11]
    s_add_u32 s54, s35, s64
    v_and_b32 v34, s60, v31
    v_fmac_f32 v33, v32, v6
    v_mfma_f32_16x16x32_bf16 v[12:15], a[84:87], a[224:227], v[12:15]
    ds_read_b128 a[224:227], v36 offset:18432
    v_fmac_f32 v35, v34, v7
    v_mfma_f32_16x16x32_bf16 v[12:15], a[92:95], a[228:231], v[12:15]
    s_waitcnt lgkmcnt(7)
    ds_read_b128 a[228:231], v36 offset:19456
    v_cvt_pk_bf16_f32 v31, v33, v35
    v_mfma_f32_16x16x32_bf16 v[8:11], a[96:99], a[232:235], v[8:11]
    buffer_load_dwordx4 v42, s[24:27], s35 offen offset:2048 sc1 lds
    v_mfma_f32_16x16x32_bf16 v[8:11], a[104:107], a[236:239], v[8:11]
    ds_write_b64 v49, v[30:31] offset:32
    v_mfma_f32_16x16x32_bf16 v[12:15], a[100:103], a[232:235], v[12:15]
    ds_read_b128 a[232:235], v36 offset:20480
    v_mfma_f32_16x16x32_bf16 v[12:15], a[108:111], a[236:239], v[12:15]
    s_waitcnt lgkmcnt(8)
    ds_read_b128 a[236:239], v36 offset:21504
    v_mfma_f32_16x16x32_bf16 v[8:11], a[112:115], a[208:211], v[8:11]
    buffer_load_dwordx4 v42, s[24:27], s35 offen offset:3072 sc1 lds
    v_mfma_f32_16x16x32_bf16 v[8:11], a[120:123], a[212:215], v[8:11]
    s_addk_i32 m0, 4096
    v_mfma_f32_16x16x32_bf16 v[12:15], a[116:119], a[208:211], v[12:15]
    s_add_u32 s0, s0, s63
    ds_read_b128 a[208:211], v36 offset:22528
    v_mfma_f32_16x16x32_bf16 v[12:15], a[124:127], a[212:215], v[12:15]
    s_waitcnt lgkmcnt(6)
    ds_read_b128 a[212:215], v36 offset:23552
    v_mfma_f32_16x16x32_bf16 v[8:11], a[128:131], a[216:219], v[8:11]
    v_mfma_f32_16x16x32_bf16 v[8:11], a[136:139], a[220:223], v[8:11]
    buffer_load_dwordx4 v42, s[24:27], s54 offen offset:0 sc1 lds
    v_mfma_f32_16x16x32_bf16 v[12:15], a[132:135], a[216:219], v[12:15]
    ds_read_b128 a[216:219], v36 offset:24576
    v_mfma_f32_16x16x32_bf16 v[12:15], a[140:143], a[220:223], v[12:15]
    s_waitcnt lgkmcnt(6)
    ds_read_b128 a[220:223], v36 offset:25600
    v_add_u32 v36, 26624, v36
    v_mfma_f32_16x16x32_bf16 v[8:11], a[144:147], a[224:227], v[8:11]
    v_mfma_f32_16x16x32_bf16 v[8:11], a[152:155], a[228:231], v[8:11]
    buffer_load_dwordx4 v42, s[24:27], s54 offen offset:1024 sc1 lds
    v_mfma_f32_16x16x32_bf16 v[12:15], a[148:151], a[224:227], v[12:15]
    s_mov_b32 m0, s34
    v_mfma_f32_16x16x32_bf16 v[12:15], a[156:159], a[228:231], v[12:15]
    s_waitcnt lgkmcnt(4)
    v_mfma_f32_16x16x32_bf16 v[8:11], a[160:163], a[232:235], v[8:11]
    v_mfma_f32_16x16x32_bf16 v[8:11], a[168:171], a[236:239], v[8:11]
    buffer_load_dwordx4 v42, s[24:27], s0 offen offset:0 sc1 lds
    s_waitcnt vmcnt(8) lgkmcnt(0)
    s_barrier
    v_mfma_f32_16x16x32_bf16 v[12:15], a[164:167], a[232:235], v[12:15]
    ds_read_b128 a[224:227], v36 offset:0
    v_accvgpr_read_b32 v28, a244
    v_mfma_f32_16x16x32_bf16 v[12:15], a[172:175], a[236:239], v[12:15]
    ds_read_b128 a[228:231], v36 offset:1024
    v_accvgpr_read_b32 v29, a245
    v_mfma_f32_16x16x32_bf16 v[8:11], a[176:179], a[208:211], v[8:11]
    ds_read_b128 a[232:235], v36 offset:2048
    v_accvgpr_read_b32 v30, a246
    v_mfma_f32_16x16x32_bf16 v[8:11], a[184:187], a[212:215], v[8:11]
    ds_read_b128 a[236:239], v36 offset:3072
    v_accvgpr_read_b32 v31, a247
L_page7:
    s_cbranch_execz L_walk_back
    v_mfma_f32_16x16x32_bf16 v[12:15], a[180:183], a[208:211], v[12:15]
    ds_read_b128 a[208:211], v36 offset:4096
    ds_read_b128 v[52:55], v50 offset:0
    s_add_u32 s53, s53, s63
    v_mfma_f32_16x16x32_bf16 v[12:15], a[188:191], a[212:215], v[12:15]
    ds_read_b128 a[212:215], v36 offset:5120
    v_lshlrev_b32 v33, 16, v24
    v_mfma_f32_16x16x32_bf16 v[8:11], a[192:195], a[216:219], v[8:11]
    v_and_b32 v35, s60, v24
    v_lshlrev_b32 v32, 16, v28
    v_mfma_f32_16x16x32_bf16 v[8:11], a[200:203], a[220:223], v[8:11]
    v_and_b32 v34, s60, v28
    v_mfma_f32_16x16x32_bf16 v[12:15], a[196:199], a[216:219], v[12:15]
    ds_read_b128 a[216:219], v36 offset:6144
    v_mfma_f32_16x16x32_bf16 v[12:15], a[204:207], a[220:223], v[12:15]
    s_waitcnt lgkmcnt(6)
    ds_read_b128 a[220:223], v36 offset:7168
    v_mfma_f32_16x16x32_bf16 v[0:3], a[0:3], a[224:227], v[16:19]
    v_mfma_f32_16x16x32_bf16 v[0:3], a[8:11], a[228:231], v[0:3]
    v_fmac_f32 v33, v32, v8
    v_fmac_f32 v35, v34, v9
    v_mfma_f32_16x16x32_bf16 v[4:7], a[4:7], a[224:227], v[20:23]
    ds_read_b128 a[224:227], v36 offset:8192
    v_cvt_pk_bf16_f32 v28, v33, v35
    v_mfma_f32_16x16x32_bf16 v[4:7], a[12:15], a[228:231], v[4:7]
    s_waitcnt lgkmcnt(6)
    ds_read_b128 a[228:231], v36 offset:9216
    v_lshlrev_b32 v33, 16, v25
    v_mfma_f32_16x16x32_bf16 v[0:3], a[16:19], a[232:235], v[0:3]
    s_waitcnt lgkmcnt(5)
    buffer_store_dwordx4 v[52:55], v48, s[28:31], s53 offen sc1 nt
    v_mfma_f32_16x16x32_bf16 v[0:3], a[24:27], a[236:239], v[0:3]
    v_and_b32 v35, s60, v25
    v_lshlrev_b32 v32, 16, v29
    v_mfma_f32_16x16x32_bf16 v[4:7], a[20:23], a[232:235], v[4:7]
    ds_read_b128 a[232:235], v36 offset:10240
    v_and_b32 v34, s60, v29
    v_mfma_f32_16x16x32_bf16 v[4:7], a[28:31], a[236:239], v[4:7]
    s_waitcnt lgkmcnt(5)
    ds_read_b128 a[236:239], v36 offset:11264
    v_fmac_f32 v33, v32, v10
    v_mfma_f32_16x16x32_bf16 v[0:3], a[32:35], a[208:211], v[0:3]
    v_fmac_f32 v35, v34, v11
    v_cvt_pk_bf16_f32 v29, v33, v35
    v_mfma_f32_16x16x32_bf16 v[0:3], a[40:43], a[212:215], v[0:3]
    v_lshlrev_b32 v33, 16, v26
    v_and_b32 v35, s60, v26
    v_mfma_f32_16x16x32_bf16 v[4:7], a[36:39], a[208:211], v[4:7]
    ds_read_b128 a[208:211], v36 offset:12288
    v_lshlrev_b32 v32, 16, v30
    v_mfma_f32_16x16x32_bf16 v[4:7], a[44:47], a[212:215], v[4:7]
    s_waitcnt lgkmcnt(5)
    ds_read_b128 a[212:215], v36 offset:13312
    v_and_b32 v34, s60, v30
    v_mfma_f32_16x16x32_bf16 v[0:3], a[48:51], a[216:219], v[0:3]
    v_fmac_f32 v33, v32, v12
    v_fmac_f32 v35, v34, v13
    v_mfma_f32_16x16x32_bf16 v[0:3], a[56:59], a[220:223], v[0:3]
    v_cvt_pk_bf16_f32 v30, v33, v35
    ds_write_b64 v49, v[28:29] offset:8192
    v_mfma_f32_16x16x32_bf16 v[4:7], a[52:55], a[216:219], v[4:7]
    ds_read_b128 a[216:219], v36 offset:14336
    v_lshlrev_b32 v33, 16, v27
    v_mfma_f32_16x16x32_bf16 v[4:7], a[60:63], a[220:223], v[4:7]
    s_waitcnt lgkmcnt(6)
    ds_read_b128 a[220:223], v36 offset:15360
    v_and_b32 v35, s60, v27
    v_mfma_f32_16x16x32_bf16 v[0:3], a[64:67], a[224:227], v[0:3]
    ds_read_b128 v[24:27], v44 offset:26624
    v_lshlrev_b32 v32, 16, v31
    v_mfma_f32_16x16x32_bf16 v[0:3], a[72:75], a[228:231], v[0:3]
    v_and_b32 v34, s60, v31
    v_fmac_f32 v33, v32, v14
    v_mfma_f32_16x16x32_bf16 v[4:7], a[68:71], a[224:227], v[4:7]
    ds_read_b128 a[224:227], v36 offset:16384
    v_fmac_f32 v35, v34, v15
    v_mfma_f32_16x16x32_bf16 v[4:7], a[76:79], a[228:231], v[4:7]
    s_waitcnt lgkmcnt(7)
    ds_read_b128 a[228:231], v36 offset:17408
    v_cvt_pk_bf16_f32 v31, v33, v35
    v_mfma_f32_16x16x32_bf16 v[0:3], a[80:83], a[232:235], v[0:3]
    ds_write_b64 v49, v[30:31] offset:8224
    v_mfma_f32_16x16x32_bf16 v[0:3], a[88:91], a[236:239], v[0:3]
    v_mfma_f32_16x16x32_bf16 v[4:7], a[84:87], a[232:235], v[4:7]
    ds_read_b128 a[232:235], v36 offset:18432
    v_mfma_f32_16x16x32_bf16 v[4:7], a[92:95], a[236:239], v[4:7]
    s_waitcnt lgkmcnt(8)
    ds_read_b128 a[236:239], v36 offset:19456
    v_mfma_f32_16x16x32_bf16 v[0:3], a[96:99], a[208:211], v[0:3]
    v_mfma_f32_16x16x32_bf16 v[0:3], a[104:107], a[212:215], v[0:3]
    v_mfma_f32_16x16x32_bf16 v[4:7], a[100:103], a[208:211], v[4:7]
    ds_read_b128 a[208:211], v36 offset:20480
    v_mfma_f32_16x16x32_bf16 v[4:7], a[108:111], a[212:215], v[4:7]
    s_waitcnt lgkmcnt(7)
    ds_read_b128 a[212:215], v36 offset:21504
    v_mfma_f32_16x16x32_bf16 v[0:3], a[112:115], a[216:219], v[0:3]
    v_mfma_f32_16x16x32_bf16 v[0:3], a[120:123], a[220:223], v[0:3]
    v_mfma_f32_16x16x32_bf16 v[4:7], a[116:119], a[216:219], v[4:7]
    ds_read_b128 a[216:219], v36 offset:22528
    v_mfma_f32_16x16x32_bf16 v[4:7], a[124:127], a[220:223], v[4:7]
    s_waitcnt lgkmcnt(6)
    ds_read_b128 a[220:223], v36 offset:23552
    v_mfma_f32_16x16x32_bf16 v[0:3], a[128:131], a[224:227], v[0:3]
    v_mfma_f32_16x16x32_bf16 v[0:3], a[136:139], a[228:231], v[0:3]
    v_mfma_f32_16x16x32_bf16 v[4:7], a[132:135], a[224:227], v[4:7]
    ds_read_b128 a[224:227], v36 offset:24576
    v_mfma_f32_16x16x32_bf16 v[4:7], a[140:143], a[228:231], v[4:7]
    s_waitcnt lgkmcnt(5)
    ds_read_b128 a[228:231], v36 offset:25600
    v_add_u32 v36, 26624, v36
    v_mfma_f32_16x16x32_bf16 v[0:3], a[144:147], a[232:235], v[0:3]
    v_mfma_f32_16x16x32_bf16 v[0:3], a[152:155], a[236:239], v[0:3]
    v_mfma_f32_16x16x32_bf16 v[4:7], a[148:151], a[232:235], v[4:7]
    v_mfma_f32_16x16x32_bf16 v[4:7], a[156:159], a[236:239], v[4:7]
    s_waitcnt lgkmcnt(4)
    v_mfma_f32_16x16x32_bf16 v[0:3], a[160:163], a[208:211], v[0:3]
    v_mfma_f32_16x16x32_bf16 v[0:3], a[168:171], a[212:215], v[0:3]
    s_waitcnt vmcnt(1) lgkmcnt(0)
    s_barrier
    v_mfma_f32_16x16x32_bf16 v[4:7], a[164:167], a[208:211], v[4:7]
    ds_read_b128 a[232:235], v36 offset:0
    v_accvgpr_read_b32 v28, a248
    v_mfma_f32_16x16x32_bf16 v[4:7], a[172:175], a[212:215], v[4:7]
    ds_read_b128 a[236:239], v36 offset:1024
    v_accvgpr_read_b32 v29, a249
    v_mfma_f32_16x16x32_bf16 v[0:3], a[176:179], a[216:219], v[0:3]
    ds_read_b128 a[208:211], v36 offset:2048
    v_accvgpr_read_b32 v30, a250
    v_mfma_f32_16x16x32_bf16 v[0:3], a[184:187], a[220:223], v[0:3]
    ds_read_b128 a[212:215], v36 offset:3072
    v_accvgpr_read_b32 v31, a251
    v_mfma_f32_16x16x32_bf16 v[4:7], a[180:183], a[216:219], v[4:7]
    ds_read_b128 a[216:219], v36 offset:4096
    ds_read_b128 v[52:55], v50 offset:8192
    s_add_u32 s53, s53, s63
    v_mfma_f32_16x16x32_bf16 v[4:7], a[188:191], a[220:223], v[4:7]
    ds_read_b128 a[220:223], v36 offset:5120
    v_lshlrev_b32 v33, 16, v24
    v_mfma_f32_16x16x32_bf16 v[0:3], a[192:195], a[224:227], v[0:3]
    v_and_b32 v35, s60, v24
    v_lshlrev_b32 v32, 16, v28
    v_mfma_f32_16x16x32_bf16 v[0:3], a[200:203], a[228:231], v[0:3]
    v_and_b32 v34, s60, v28
    v_mfma_f32_16x16x32_bf16 v[4:7], a[196:199], a[224:227], v[4:7]
    ds_read_b128 a[224:227], v36 offset:6144
    v_mfma_f32_16x16x32_bf16 v[4:7], a[204:207], a[228:231], v[4:7]
    s_waitcnt lgkmcnt(6)
    ds_read_b128 a[228:231], v36 offset:7168
    v_mfma_f32_16x16x32_bf16 v[8:11], a[0:3], a[232:235], v[16:19]
    v_mfma_f32_16x16x32_bf16 v[8:11], a[8:11], a[236:239], v[8:11]
    v_fmac_f32 v33, v32, v0
    v_fmac_f32 v35, v34, v1
    v_mfma_f32_16x16x32_bf16 v[12:15], a[4:7], a[232:235], v[20:23]
    ds_read_b128 a[232:235], v36 offset:8192
    v_cvt_pk_bf16_f32 v28, v33, v35
    v_mfma_f32_16x16x32_bf16 v[12:15], a[12:15], a[236:239], v[12:15]
    s_waitcnt lgkmcnt(6)
    ds_read_b128 a[236:239], v36 offset:9216
    v_lshlrev_b32 v33, 16, v25
    v_mfma_f32_16x16x32_bf16 v[8:11], a[16:19], a[208:211], v[8:11]
    s_waitcnt lgkmcnt(5)
    buffer_store_dwordx4 v[52:55], v48, s[28:31], s53 offen sc1 nt
    v_mfma_f32_16x16x32_bf16 v[8:11], a[24:27], a[212:215], v[8:11]
    v_and_b32 v35, s60, v25
    v_lshlrev_b32 v32, 16, v29
    v_mfma_f32_16x16x32_bf16 v[12:15], a[20:23], a[208:211], v[12:15]
    ds_read_b128 a[208:211], v36 offset:10240
    v_and_b32 v34, s60, v29
    v_mfma_f32_16x16x32_bf16 v[12:15], a[28:31], a[212:215], v[12:15]
    s_waitcnt lgkmcnt(5)
    ds_read_b128 a[212:215], v36 offset:11264
    v_fmac_f32 v33, v32, v2
    v_mfma_f32_16x16x32_bf16 v[8:11], a[32:35], a[216:219], v[8:11]
    v_fmac_f32 v35, v34, v3
    v_cvt_pk_bf16_f32 v29, v33, v35
    v_mfma_f32_16x16x32_bf16 v[8:11], a[40:43], a[220:223], v[8:11]
    v_lshlrev_b32 v33, 16, v26
    v_and_b32 v35, s60, v26
    v_mfma_f32_16x16x32_bf16 v[12:15], a[36:39], a[216:219], v[12:15]
    ds_read_b128 a[216:219], v36 offset:12288
    v_lshlrev_b32 v32, 16, v30
    v_mfma_f32_16x16x32_bf16 v[12:15], a[44:47], a[220:223], v[12:15]
    s_waitcnt lgkmcnt(5)
    ds_read_b128 a[220:223], v36 offset:13312
    v_and_b32 v34, s60, v30
    v_mfma_f32_16x16x32_bf16 v[8:11], a[48:51], a[224:227], v[8:11]
    v_fmac_f32 v33, v32, v4
    v_fmac_f32 v35, v34, v5
    v_mfma_f32_16x16x32_bf16 v[8:11], a[56:59], a[228:231], v[8:11]
    v_cvt_pk_bf16_f32 v30, v33, v35
    ds_write_b64 v49, v[28:29] offset:0
    v_mfma_f32_16x16x32_bf16 v[12:15], a[52:55], a[224:227], v[12:15]
    ds_read_b128 a[224:227], v36 offset:14336
    v_lshlrev_b32 v33, 16, v27
    v_mfma_f32_16x16x32_bf16 v[12:15], a[60:63], a[228:231], v[12:15]
    s_waitcnt lgkmcnt(6)
    ds_read_b128 a[228:231], v36 offset:15360
    v_and_b32 v35, s60, v27
    v_mfma_f32_16x16x32_bf16 v[8:11], a[64:67], a[232:235], v[8:11]
    ds_read_b128 v[24:27], v44 offset:53248
    v_lshlrev_b32 v32, 16, v31
    v_mfma_f32_16x16x32_bf16 v[8:11], a[72:75], a[236:239], v[8:11]
    v_and_b32 v34, s60, v31
    v_fmac_f32 v33, v32, v6
    v_mfma_f32_16x16x32_bf16 v[12:15], a[68:71], a[232:235], v[12:15]
    ds_read_b128 a[232:235], v36 offset:16384
    v_fmac_f32 v35, v34, v7
    v_mfma_f32_16x16x32_bf16 v[12:15], a[76:79], a[236:239], v[12:15]
    s_waitcnt lgkmcnt(7)
    ds_read_b128 a[236:239], v36 offset:17408
    v_cvt_pk_bf16_f32 v31, v33, v35
    v_mfma_f32_16x16x32_bf16 v[8:11], a[80:83], a[208:211], v[8:11]
    ds_write_b64 v49, v[30:31] offset:32
    v_mfma_f32_16x16x32_bf16 v[8:11], a[88:91], a[212:215], v[8:11]
    v_mfma_f32_16x16x32_bf16 v[12:15], a[84:87], a[208:211], v[12:15]
    ds_read_b128 a[208:211], v36 offset:18432
    v_mfma_f32_16x16x32_bf16 v[12:15], a[92:95], a[212:215], v[12:15]
    s_waitcnt lgkmcnt(8)
    ds_read_b128 a[212:215], v36 offset:19456
    v_mfma_f32_16x16x32_bf16 v[8:11], a[96:99], a[216:219], v[8:11]
    v_mfma_f32_16x16x32_bf16 v[8:11], a[104:107], a[220:223], v[8:11]
    v_mfma_f32_16x16x32_bf16 v[12:15], a[100:103], a[216:219], v[12:15]
    ds_read_b128 a[216:219], v36 offset:20480
    v_mfma_f32_16x16x32_bf16 v[12:15], a[108:111], a[220:223], v[12:15]
    s_waitcnt lgkmcnt(7)
    ds_read_b128 a[220:223], v36 offset:21504
    v_mfma_f32_16x16x32_bf16 v[8:11], a[112:115], a[224:227], v[8:11]
    v_mfma_f32_16x16x32_bf16 v[8:11], a[120:123], a[228:231], v[8:11]
    v_mfma_f32_16x16x32_bf16 v[12:15], a[116:119], a[224:227], v[12:15]
    ds_read_b128 a[224:227], v36 offset:22528
    v_mfma_f32_16x16x32_bf16 v[12:15], a[124:127], a[228:231], v[12:15]
    s_waitcnt lgkmcnt(6)
    ds_read_b128 a[228:231], v36 offset:23552
    v_mfma_f32_16x16x32_bf16 v[8:11], a[128:131], a[232:235], v[8:11]
    v_mfma_f32_16x16x32_bf16 v[8:11], a[136:139], a[236:239], v[8:11]
    v_mfma_f32_16x16x32_bf16 v[12:15], a[132:135], a[232:235], v[12:15]
    ds_read_b128 a[232:235], v36 offset:24576
    v_mfma_f32_16x16x32_bf16 v[12:15], a[140:143], a[236:239], v[12:15]
    s_waitcnt lgkmcnt(5)
    ds_read_b128 a[236:239], v36 offset:25600
    v_mfma_f32_16x16x32_bf16 v[8:11], a[144:147], a[208:211], v[8:11]
    v_mfma_f32_16x16x32_bf16 v[8:11], a[152:155], a[212:215], v[8:11]
    v_mfma_f32_16x16x32_bf16 v[12:15], a[148:151], a[208:211], v[12:15]
    v_mfma_f32_16x16x32_bf16 v[12:15], a[156:159], a[212:215], v[12:15]
    s_waitcnt lgkmcnt(4)
    v_mfma_f32_16x16x32_bf16 v[8:11], a[160:163], a[216:219], v[8:11]
    v_mfma_f32_16x16x32_bf16 v[8:11], a[168:171], a[220:223], v[8:11]
    s_waitcnt lgkmcnt(0)
    s_barrier
    v_mfma_f32_16x16x32_bf16 v[12:15], a[164:167], a[216:219], v[12:15]
    ds_read_b128 v[52:55], v50 offset:0
    v_accvgpr_read_b32 v28, a252
    s_add_u32 s53, s53, s63
    v_mfma_f32_16x16x32_bf16 v[12:15], a[172:175], a[220:223], v[12:15]
    v_accvgpr_read_b32 v29, a253
    v_accvgpr_read_b32 v30, a254
    v_mfma_f32_16x16x32_bf16 v[8:11], a[176:179], a[224:227], v[8:11]
    v_accvgpr_read_b32 v31, a255
    v_lshlrev_b32 v33, 16, v24
    v_mfma_f32_16x16x32_bf16 v[8:11], a[184:187], a[228:231], v[8:11]
    v_and_b32 v35, s60, v24
    v_lshlrev_b32 v32, 16, v28
    v_mfma_f32_16x16x32_bf16 v[12:15], a[180:183], a[224:227], v[12:15]
    v_and_b32 v34, s60, v28
    v_mfma_f32_16x16x32_bf16 v[12:15], a[188:191], a[228:231], v[12:15]
    v_mfma_f32_16x16x32_bf16 v[8:11], a[192:195], a[232:235], v[8:11]
    v_mfma_f32_16x16x32_bf16 v[8:11], a[200:203], a[236:239], v[8:11]
    v_mfma_f32_16x16x32_bf16 v[12:15], a[196:199], a[232:235], v[12:15]
    v_mfma_f32_16x16x32_bf16 v[12:15], a[204:207], a[236:239], v[12:15]
    s_waitcnt lgkmcnt(0)
    buffer_store_dwordx4 v[52:55], v48, s[28:31], s53 offen sc1 nt
    s_nop 3
    v_fmac_f32 v33, v32, v8
    v_fmac_f32 v35, v34, v9
    v_cvt_pk_bf16_f32 v28, v33, v35
    v_lshlrev_b32 v33, 16, v25
    v_and_b32 v35, s60, v25
    v_lshlrev_b32 v32, 16, v29
    v_and_b32 v34, s60, v29
    v_fmac_f32 v33, v32, v10
    v_fmac_f32 v35, v34, v11
    v_cvt_pk_bf16_f32 v29, v33, v35
    v_lshlrev_b32 v33, 16, v26
    v_and_b32 v35, s60, v26
    v_lshlrev_b32 v32, 16, v30
    v_and_b32 v34, s60, v30
    v_fmac_f32 v33, v32, v12
    v_fmac_f32 v35, v34, v13
    ds_write_b64 v49, v[28:29] offset:8192
    v_cvt_pk_bf16_f32 v30, v33, v35
    v_lshlrev_b32 v33, 16, v27
    v_and_b32 v35, s60, v27
    v_lshlrev_b32 v32, 16, v31
    v_and_b32 v34, s60, v31
    v_fmac_f32 v33, v32, v14
    v_fmac_f32 v35, v34, v15
    v_cvt_pk_bf16_f32 v31, v33, v35
    ds_write_b64 v49, v[30:31] offset:8224
    s_waitcnt lgkmcnt(0)
    s_barrier
    ds_read_b128 v[52:55], v50 offset:8192
    s_add_u32 s53, s53, s63
    s_waitcnt lgkmcnt(0)
    buffer_store_dwordx4 v[52:55], v48, s[28:31], s53 offen sc1 nt
    s_endpgm
L_slow8:
    s_mov_b32 s50, 0
L_spin8:
    buffer_load_dword v47, v46, s[24:27], s49 offen sc1
    s_waitcnt vmcnt(0)
    v_cmp_ne_u32 vcc, s45, v47
    s_cbranch_vccz L_back8
    s_add_u32 s50, s50, 1
    s_cmp_lt_u32 s50, 200000
    s_cbranch_scc1 L_spin8
    s_branch L_back8
L_slow9:
    s_mov_b32 s50, 0
L_spin9:
    buffer_load_dword v47, v46, s[24:27], s49 offen sc1
    s_waitcnt vmcnt(0)
    v_cmp_ne_u32 vcc, s45, v47
    s_cbranch_vccz L_back9
    s_add_u32 s50, s50, 1
    s_cmp_lt_u32 s50, 200000
    s_cbranch_scc1 L_spin9
    s_branch L_back9
L_slow10:
    s_mov_b32 s50, 0
L_spin10:
    buffer_load_dword v47, v46, s[24:27], s49 offen sc1
    s_waitcnt vmcnt(0)
    v_cmp_ne_u32 vcc, s45, v47
    s_cbranch_vccz L_back10
    s_add_u32 s50, s50, 1
    s_cmp_lt_u32 s50, 200000
    s_cbranch_scc1 L_spin10
    s_branch L_back10
L_slow11:
    s_mov_b32 s50, 0
L_spin11:
    buffer_load_dword v47, v46, s[24:27], s49 offen sc1
    s_waitcnt vmcnt(0)
    v_cmp_ne_u32 vcc, s45, v47
    s_cbranch_vccz L_back11
    s_add_u32 s50, s50, 1
    s_cmp_lt_u32 s50, 200000
    s_cbranch_scc1 L_spin11
    s_branch L_back11
L_slow12:
    s_mov_b32 s50, 0
L_spin12:
    buffer_load_dword v47, v46, s[24:27], s49 offen sc1
    s_waitcnt vmcnt(0)
    v_cmp_ne_u32 vcc, s45, v47
    s_cbranch_vccz L_back12
    s_add_u32 s50, s50, 1
    s_cmp_lt_u32 s50, 200000
    s_cbranch_scc1 L_spin12
    s_branch L_back12
L_slow13:
    s_mov_b32 s50, 0
L_spin13:
    buffer_load_dword v47, v46, s[24:27], s49 offen sc1
    s_waitcnt vmcnt(0)
    v_cmp_ne_u32 vcc, s45, v47
    s_cbranch_vccz L_back13
    s_add_u32 s50, s50, 1
    s_cmp_lt_u32 s50, 200000
    s_cbranch_scc1 L_spin13
    s_branch L_back13
L_slow14:
    s_mov_b32 s50, 0
L_spin14:
    buffer_load_dword v47, v46, s[24:27], s49 offen sc1
    s_waitcnt vmcnt(0)
    v_cmp_ne_u32 vcc, s45, v47
    s_cbranch_vccz L_back14
    s_add_u32 s50, s50, 1
    s_cmp_lt_u32 s50, 200000
    s_cbranch_scc1 L_spin14
    s_branch L_back14
L_slow15:
    s_mov_b32 s50, 0
L_spin15:
    buffer_load_dword v47, v46, s[24:27], s49 offen sc1
    s_waitcnt vmcnt(0)
    v_cmp_ne_u32 vcc, s45, v47
    s_cbranch_vccz L_back15
    s_add_u32 s50, s50, 1
    s_cmp_lt_u32 s50, 200000
    s_cbranch_scc1 L_spin15
    s_branch L_back15
L_slow16:
    s_mov_b32 s50, 0
L_spin16:
    buffer_load_dword v47, v46, s[24:27], s49 offen sc1
    s_waitcnt vmcnt(0)
    v_cmp_ne_u32 vcc, s45, v47
    s_cbranch_vccz L_back16
    s_add_u32 s50, s50, 1
    s_cmp_lt_u32 s50, 200000
    s_cbranch_scc1 L_spin16
    s_branch L_back16
L_slow17:
    s_mov_b32 s50, 0
L_spin17:
    buffer_load_dword v47, v46, s[24:27], s49 offen sc1
    s_waitcnt vmcnt(0)
    v_cmp_ne_u32 vcc, s45, v47
    s_cbranch_vccz L_back17
    s_add_u32 s50, s50, 1
    s_cmp_lt_u32 s50, 200000
    s_cbranch_scc1 L_spin17
    s_branch L_back17
L_slow18:
    s_mov_b32 s50, 0
L_spin18:
    buffer_load_dword v47, v46, s[24:27], s49 offen sc1
    s_waitcnt vmcnt(0)
    v_cmp_ne_u32 vcc, s45, v47
    s_cbranch_vccz L_back18
    s_add_u32 s50, s50, 1
    s_cmp_lt_u32 s50, 200000
    s_cbranch_scc1 L_spin18
    s_branch L_back18
L_slow19:
    s_mov_b32 s50, 0
L_spin19:
    buffer_load_dword v47, v46, s[24:27], s49 offen sc1
    s_waitcnt vmcnt(0)
    v_cmp_ne_u32 vcc, s45, v47
    s_cbranch_vccz L_back19
    s_add_u32 s50, s50, 1
    s_cmp_lt_u32 s50, 200000
    s_cbranch_scc1 L_spin19
    s_branch L_back19
L_slow20:
    s_mov_b32 s50, 0
L_spin20:
    buffer_load_dword v47, v46, s[24:27], s49 offen sc1
    s_waitcnt vmcnt(0)
    v_cmp_ne_u32 vcc, s45, v47
    s_cbranch_vccz L_back20
    s_add_u32 s50, s50, 1
    s_cmp_lt_u32 s50, 200000
    s_cbranch_scc1 L_spin20
    s_branch L_back20
L_slow21:
    s_mov_b32 s50, 0
L_spin21:
    buffer_load_dword v47, v46, s[24:27], s49 offen sc1
    s_waitcnt vmcnt(0)
    v_cmp_ne_u32 vcc, s45, v47
    s_cbranch_vccz L_back21
    s_add_u32 s50, s50, 1
    s_cmp_lt_u32 s50, 200000
    s_cbranch_scc1 L_spin21
    s_branch L_back21
L_slow22:
    s_mov_b32 s50, 0
L_spin22:
    buffer_load_dword v47, v46, s[24:27], s49 offen sc1
    s_waitcnt vmcnt(0)
    v_cmp_ne_u32 vcc, s45, v47
    s_cbranch_vccz L_back22
    s_add_u32 s50, s50, 1
    s_cmp_lt_u32 s50, 200000
    s_cbranch_scc1 L_spin22
    s_branch L_back22
L_slow23:
    s_mov_b32 s50, 0
L_spin23:
    buffer_load_dword v47, v46, s[24:27], s49 offen sc1
    s_waitcnt vmcnt(0)
    v_cmp_ne_u32 vcc, s45, v47
    s_cbranch_vccz L_back23
    s_add_u32 s50, s50, 1
    s_cmp_lt_u32 s50, 200000
    s_cbranch_scc1 L_spin23
    s_branch L_back23
L_slow_nonce:
    s_mov_b32 s50, 0
    v_mov_b32 v34, 0
L_spin_nonce:
    buffer_load_dwordx2 v[32:33], v34, s[36:39], 0 offen sc1
    s_waitcnt vmcnt(0)
    v_cmp_eq_u32 vcc, 0, v33
    s_cbranch_vccz L_back_nonce
    s_add_u32 s50, s50, 1
    s_cmp_lt_u32 s50, 200000
    s_cbranch_scc1 L_spin_nonce
    s_branch L_back_nonce
L_prefetcher:
    s_sub_u32 s51, s51, 28
    s_lshl_b32 s51, s51, 2
    s_add_u32 s51, s51, s3
    v_lshlrev_b32 v3, 7, v2
    s_getpc_b64 s[52:53]
L_pc:
    s_sub_u32 s52, s52, L_pc-standalone__cross_network_dcn__recsys_kernel
    s_subb_u32 s53, s53, 0
    s_mov_b32 s4, s52
    s_and_b32 s5, s53, 0xffff
    s_mov_b32 s6, L_code_end-standalone__cross_network_dcn__recsys_kernel
    s_mov_b32 s7, 0x00020000
    s_lshl_b32 s54, s51, 13
    buffer_load_dword v5, v3, s[4:7], s54 offen
    s_waitcnt lgkmcnt(0)
    s_and_b32 s55, s2, 7
    s_lshl_b32 s55, s55, 4
    s_add_u32 s55, s55, s51
    s_lshl_b32 s55, s55, 13
    s_mov_b32 s18, 6815744
    s_mov_b32 s19, 0x00020000
    s_and_b32 s40, s2, 7
    s_lshl_b32 s40, s40, 2
    s_lshr_b32 s41, s51, 2
    s_add_u32 s40, s40, s41
    s_mul_i32 s40, s40, 212992
    s_lshl_b32 s41, s3, 13
    s_add_u32 s40, s40, s41
    s_add_u32 s41, s40, 26624
    buffer_load_dword v4, v3, s[16:19], s41 offen
    s_add_u32 s41, s40, 59392
    buffer_load_dword v4, v3, s[16:19], s41 offen
    s_add_u32 s41, s54, 1384448
L_pf_loop1:
    buffer_load_dword v4, v3, s[20:23], s41 offen
    s_waitcnt vmcnt(2)
    s_add_u32 s41, s41, 131072
    s_cmp_lt_u32 s41, 4153344
    s_cbranch_scc1 L_pf_loop1
L_end:
    s_endpgm
L_code_end:
.section .rodata,"a"
.p2align 6
.amdhsa_kernel standalone__cross_network_dcn__recsys_kernel
  .amdhsa_next_free_vgpr 512
  .amdhsa_next_free_sgpr 102
  .amdhsa_accum_offset 256
  .amdhsa_group_segment_fixed_size 0
  .amdhsa_kernarg_size 48
  .amdhsa_user_sgpr_count 2
  .amdhsa_user_sgpr_kernarg_segment_ptr 1
  .amdhsa_system_sgpr_workgroup_id_x 1
.end_amdhsa_kernel
```
